```python
import torch

def _softmax(x, axis=-1):
    return torch.softmax(x, dim=axis)
def _gelu(x):
    return torch.nn.functional.gelu(x, approximate="tanh")
def _silu(x):
    return torch.nn.functional.silu(x)
def _sigmoid(x):
    return torch.sigmoid(x)
def _layernorm(x, axis=-1, eps=1e-5):
    m = x.mean(dim=axis, keepdim=True)
    v = x.var(dim=axis, keepdim=True, unbiased=False)
    return (x - m) / torch.sqrt(v + eps)
def _scatter_add(tgt, idx, src, axis=0):
    return tgt.clone().index_add_(axis, idx, src)
def _segment_sum(src, seg, n):
    out = torch.zeros((n,) + src.shape[1:], dtype=src.dtype)
    return out.index_add_(0, seg, src)
def _pad(x, pw):
    flat = tuple(v for pair in reversed(pw) for v in pair)
    return torch.nn.functional.pad(x, flat)

kernel_name = 'gated_mix__sliding_block__linear_attn_block__prompt'

def setup_inputs():

    _w = (lambda a: (lambda t: t.to(torch.bfloat16) if t.is_floating_point() else t)(torch.as_tensor(a)))
    def _A_setup():
        B, S, D = 1, 2048, 448
        return {
            "x": _w((lambda *s: torch.randn(*s, dtype=torch.bfloat16) * 0.05)(B, S, D)),
            "wqkv": _w((lambda *s: torch.randn(*s, dtype=torch.bfloat16) * 1.6)(D, 3 * D)),
            "wo": _w((lambda *s: torch.randn(*s, dtype=torch.bfloat16) * 0.05)(D, D)),
        }
    _A_in = _A_setup()

    def _B_setup():
        B, S, D = 1, 2048, 448
        return {
            "x": _w((lambda *s: torch.randn(*s, dtype=torch.bfloat16) * 0.05)(B, S, D)),
            "wqkv": _w((lambda *s: torch.randn(*s, dtype=torch.bfloat16) * 1.6)(D, 3 * D)),
            "wo": _w((lambda *s: torch.randn(*s, dtype=torch.bfloat16) * 0.8)(D, D)),
        }
    _B_in = _B_setup()

    return {
        "A_x": _A_in["x"],
        "A_wqkv": _A_in["wqkv"],
        "A_wo": _A_in["wo"],
        "B_x": _B_in["x"],
        "B_wqkv": _B_in["wqkv"],
        "B_wo": _B_in["wo"],
        "gate_w": _w((lambda *s: torch.randn(*s, dtype=torch.bfloat16) * 0.05)(448) * 16.0),
    }

def reference(A_x, A_wqkv, A_wo, B_x, B_wqkv, B_wo, gate_w):
    def _A_ref(x, wqkv, wo):
        B, S, D = x.shape
        H = 16; Dh = D // H; W = 256
        qkv = (lambda x, *d: x.permute(*d))((x @ wqkv).reshape(B, S, 3, H, Dh), 2, 0, 3, 1, 4)
        q, k, v = qkv[0], qkv[1], qkv[2]
        scores = torch.einsum("bhqd,bhkd->bhqk", q, k) * (Dh ** -0.5)
        idx = torch.arange(S)
        mask = (idx[:, None] - idx[None, :] >= 0) & (idx[:, None] - idx[None, :] < W)
        scores = torch.where(mask[None, None], scores, -1e9)
        p = _softmax(scores, axis=-1)
        o = torch.einsum("bhqk,bhkd->bhqd", p, v)
        return (lambda x, *d: x.permute(*d))(o, 0, 2, 1, 3).reshape(B, S, D) @ wo

    def _B_ref(x, wqkv, wo):
        B, S, D = x.shape
        H = 16; Dh = D // H
        qkv = (lambda x, *d: x.permute(*d))((x @ wqkv).reshape(B, S, 3, H, Dh), 2, 0, 3, 1, 4)
        q, k, v = qkv[0], qkv[1], qkv[2]
        phi = lambda t: torch.where(t > 0, t + 1, torch.exp(t)) + 1e-6
        pq, pk = phi(q), phi(k)
        kv = torch.einsum("bhsd,bhse->bhde", pk, v)
        z = torch.einsum("bhsd->bhd", pk)
        num = torch.einsum("bhqd,bhde->bhqe", pq, kv)
        den = torch.einsum("bhqd,bhd->bhq", pq, z)[..., None] + 1e-6
        o = num / den
        return (lambda x, *d: x.permute(*d))(o, 0, 2, 1, 3).reshape(B, S, D) @ wo

    x = A_x
    g = _sigmoid((x * gate_w).sum(-1, keepdims=True))
    a = _A_ref(x, A_wqkv, A_wo)
    b = _B_ref(x, B_wqkv, B_wo)
    return g * a + (1 - g) * b
```

```asm
; @launch grid=(256,1,1) block=(512,1,1) lds=163840
.amdgcn_target "amdgcn-amd-amdhsa--gfx950"
.text
.globl gated_mix__sliding_block__linear_attn_block__prompt_kernel
.p2align 8
.type gated_mix__sliding_block__linear_attn_block__prompt_kernel,@function
gated_mix__sliding_block__linear_attn_block__prompt_kernel:
    s_load_dwordx4 s[4:7], s[0:1], 0
    s_load_dwordx8 s[12:19], s[0:1], 32
    s_load_dwordx4 s[20:23], s[0:1], 64
    s_load_dwordx2 s[8:9], s[0:1], 16
    s_cmp_ge_u32 s2, 256
    s_cbranch_scc1 L_exit
    v_lshrrev_b32 v1, 6, v0
    v_and_b32 v0, 63, v0
    v_xor_b32_e64 v1, 4, v1
    s_nop 0
    v_readfirstlane_b32 s24, v1
    s_getpc_b64 s[38:39]
L_pc:
    s_sub_u32 s38, s38, L_pc-gated_mix__sliding_block__linear_attn_block__prompt_kernel
    s_subb_u32 s39, s39, 0
    s_lshr_b32 s29, s2, 3
    s_lshl_b32 s30, s24, 5
    s_add_u32 s29, s29, s30
    s_mul_i32 s29, s29, 256
    v_lshl_add_u32 v20, v0, 7, s29
    v_min_u32 v20, L_end-gated_mix__sliding_block__linear_attn_block__prompt_kernel-4, v20
    s_mov_b64 exec, 3
    global_load_dword v239, v20, s[38:39]
    s_mov_b64 exec, -1
    s_and_b32 s29, s2, 7
    s_lshr_b32 s30, s2, 3
    s_and_b32 s25, s29, 1
    s_lshl_b32 s25, s25, 3
    s_and_b32 s31, s30, 7
    s_add_u32 s25, s25, s31
    s_lshr_b32 s26, s29, 1
    s_lshl_b32 s26, s26, 2
    s_lshr_b32 s31, s30, 3
    s_add_u32 s26, s26, s31
    s_and_b32 s27, s25, 1
    s_lshr_b32 s28, s25, 1
    s_and_b32 s29, s2, 1
    s_xor_b32 s74, s27, s29
    s_xor_b32 s74, s74, 1
    v_lshlrev_b32 v1, 4, v0
    v_mov_b32 v10, 158720
    v_mov_b32 v11, 1
    s_and_b32 s101, s24, 3
    v_lshlrev_b32_e64 v13, 2, v0
    v_add_u32 v13, 159232, v13
    s_lshl_b32 s29, s101, 2
    s_add_u32 s29, s29, 158720
    v_writelane_b32 v13, s29, 0
    s_cmp_lt_u32 s24, 4
    s_cbranch_scc1 L_cwave
    s_cmp_ge_u32 s24, 6
    s_cbranch_scc1 L_xwave
    s_setprio 2
    s_lshl_b32 s73, s101, 10
    v_mov_b32 v12, v13
    s_mov_b32 s29, 158976
    v_writelane_b32 v12, s29, 0
    v_lshrrev_b32 v24, 3, v0
    s_lshl_b32 s29, s26, 4
    s_add_u32 s29, s29, s101
    s_lshl_b32 s29, s29, 3
    v_add_u32_e64 v25, s29, v24
    v_mul_u32_u24 v2, 896, v25
    v_lshrrev_b32 v25, 4, v0
    s_lshl_b32 s29, s101, 2
    v_add_u32 v25, s29, v25
    v_and_b32 v26, 7, v0
    v_xor_b32_e64 v25, v25, v26
    v_lshl_add_u32 v2, v25, 4, v2
    s_lshl_b32 s31, s74, 4
    s_add_u32 s30, s31, 112
    s_add_u32 s31, s31, 48
    s_mul_i32 s30, s30, s28
    s_add_u32 s30, s30, 896
    s_lshl_b32 s29, s101, 3
    v_add_u32_e64 v25, s29, v24
    v_mul_u32_u24 v3, 2688, v25
    v_bfe_u32 v25, v0, 2, 1
    v_bfe_u32 v26, v0, 4, 1
    v_xor_b32 v25, v25, v26
    v_mul_u32_u24 v26, s31, v25
    v_add3_u32 v3, v3, v26, s30
    v_and_b32_e64 v26, 3, v0
    v_lshl_add_u32 v3, v26, 4, v3
    s_mov_b32 s38, 1835008
    s_mov_b32 s39, 0x20000
    s_mov_b32 s42, 1204224
    s_mov_b32 s43, 0x20000
    s_cmp_eq_u32 s25, 15
    s_cselect_b32 s42, 0, s42
    s_mov_b32 s60, 0
    s_cmp_ge_u32 s60, 7
    s_cselect_b32 s29, 7, 0
    s_sub_u32 s60, s60, s29
    s_cmp_ge_u32 s60, 7
    s_cselect_b32 s29, 7, 0
    s_sub_u32 s60, s60, s29
    s_mov_b32 s61, s60
    s_cmp_eq_u32 s74, 0
    s_waitcnt lgkmcnt(0)
    s_mov_b32 s1, s2
    s_mov_b32 s36, s4
    s_mov_b32 s37, s5
    s_cselect_b32 s40, s12, s6
    s_cselect_b32 s41, s13, s7
    s_lshl_b32 s20, s60, 7
    s_mul_i32 s21, s60, 172032
    s_add_u32 m0, s73, 0
    s_nop 0
    buffer_load_dwordx4 v2, s[36:39], s20 offen  lds
    s_add_u32 m0, s73, 2048
    s_add_u32 s72, s20, 14336
    buffer_load_dwordx4 v2, s[36:39], s72 offen  lds
    s_add_u32 m0, s73, 4096
    s_add_u32 s72, s20, 28672
    buffer_load_dwordx4 v2, s[36:39], s72 offen  lds
    s_add_u32 m0, s73, 6144
    s_add_u32 s72, s20, 43008
    buffer_load_dwordx4 v2, s[36:39], s72 offen  lds
    s_add_u32 m0, s73, 8192
    s_add_u32 s72, s20, 57344
    buffer_load_dwordx4 v2, s[36:39], s72 offen  lds
    s_add_u32 m0, s73, 10240
    s_add_u32 s72, s20, 71680
    buffer_load_dwordx4 v2, s[36:39], s72 offen  lds
    s_add_u32 m0, s73, 12288
    s_add_u32 s72, s20, 86016
    buffer_load_dwordx4 v2, s[36:39], s72 offen  lds
    s_add_u32 m0, s73, 14336
    s_add_u32 s72, s20, 100352
    buffer_load_dwordx4 v2, s[36:39], s72 offen  lds
    s_add_u32 m0, s73, 65536
    s_nop 0
    buffer_load_dwordx4 v3, s[40:43], s21 offen  lds
    s_add_u32 m0, s73, 67584
    s_add_u32 s72, s21, 43008
    buffer_load_dwordx4 v3, s[40:43], s72 offen  lds
    s_add_u32 m0, s73, 69632
    s_add_u32 s72, s21, 86016
    buffer_load_dwordx4 v3, s[40:43], s72 offen  lds
    s_add_u32 m0, s73, 71680
    s_add_u32 s72, s21, 129024
    buffer_load_dwordx4 v3, s[40:43], s72 offen  lds
    s_add_u32 m0, s73, 73728
    s_add_u32 s72, s21, 896
    buffer_load_dwordx4 v3, s[40:43], s72 offen  lds
    s_add_u32 m0, s73, 75776
    s_add_u32 s72, s21, 43904
    buffer_load_dwordx4 v3, s[40:43], s72 offen  lds
    s_add_u32 m0, s73, 77824
    s_add_u32 s72, s21, 86912
    buffer_load_dwordx4 v3, s[40:43], s72 offen  lds
    s_add_u32 m0, s73, 79872
    s_add_u32 s72, s21, 129920
    buffer_load_dwordx4 v3, s[40:43], s72 offen  lds
    s_barrier
    s_add_u32 s60, s60, 1
    s_cmp_eq_u32 s60, 7
    s_cselect_b32 s60, 0, s60
    s_lshl_b32 s20, s60, 7
    s_mul_i32 s21, s60, 172032
    s_add_u32 m0, s73, 16384
    s_nop 0
    buffer_load_dwordx4 v2, s[36:39], s20 offen  lds
    s_mov_b32 s32, s22
    s_mov_b32 s33, s23
    s_mov_b32 s34, 16777216
    s_mov_b32 s35, 0x20000
    s_mov_b32 s44, s12
    s_mov_b32 s45, s13
    s_waitcnt vmcnt(16)
    s_add_u32 m0, s73, 18432
    s_add_u32 s72, s20, 14336
    buffer_load_dwordx4 v2, s[36:39], s72 offen  lds
    s_mov_b32 s46, 1204224
    s_mov_b32 s47, 0x20000
    s_mov_b32 s48, s6
    s_mov_b32 s49, s7
    s_mov_b32 s50, 1204224
    s_mov_b32 s51, 0x20000
    s_waitcnt vmcnt(16)
    s_add_u32 m0, s73, 20480
    s_add_u32 s72, s20, 28672
    buffer_load_dwordx4 v2, s[36:39], s72 offen  lds
    s_mov_b32 s52, s16
    s_mov_b32 s53, s17
    s_mov_b32 s54, 896
    s_mov_b32 s55, 0x20000
    v_lshrrev_b32 v24, 2, v0
    s_lshl_b32 s29, s101, 4
    s_waitcnt vmcnt(16)
    s_add_u32 m0, s73, 22528
    s_add_u32 s72, s20, 43008
    buffer_load_dwordx4 v2, s[36:39], s72 offen  lds
    v_add_u32_e64 v24, s29, v24
    v_mul_u32_u24 v4, 2688, v24
    v_and_b32_e64 v25, 3, v0
    v_lshl_add_u32 v4, v25, 4, v4
    s_mul_i32 s29, s25, 56
    s_lshl_b32 s30, s27, 3
    s_waitcnt vmcnt(16)
    s_add_u32 m0, s73, 24576
    s_add_u32 s72, s20, 57344
    buffer_load_dwordx4 v2, s[36:39], s72 offen  lds
    s_sub_u32 s29, s29, s30
    v_add_u32_e64 v4, s29, v4
    v_bfe_u32 v24, v0, 4, 1
    v_lshlrev_b32 v24, 5, v24
    v_and_b32 v25, 15, v0
    s_lshl_b32 s29, s101, 4
    s_waitcnt vmcnt(16)
    s_add_u32 m0, s73, 26624
    s_add_u32 s72, s20, 71680
    buffer_load_dwordx4 v2, s[36:39], s72 offen  lds
    v_add3_u32 v24, v24, v25, s29
    v_lshlrev_b32_e64 v27, 1, v24
    s_xor_b32 s29, s27, 1
    s_mul_i32 s29, s29, 56
    s_add_u32 s29, s29, 114688
    v_lshl_add_u32 v5, v24, 6, s29
    s_waitcnt vmcnt(16)
    s_add_u32 m0, s73, 28672
    s_add_u32 s72, s20, 86016
    buffer_load_dwordx4 v2, s[36:39], s72 offen  lds
    s_lshl_b32 s29, s61, 7
    buffer_load_ushort v16, v27, s[52:55], s29 offen
    s_add_u32 s61, s61, 1
    s_cmp_eq_u32 s61, 7
    s_cselect_b32 s61, 0, s61
    s_lshl_b32 s29, s61, 7
    buffer_load_ushort v17, v27, s[52:55], s29 offen
    s_add_u32 s61, s61, 1
    s_cmp_eq_u32 s61, 7
    s_cselect_b32 s61, 0, s61
    s_lshl_b32 s29, s61, 7
    buffer_load_ushort v18, v27, s[52:55], s29 offen
    s_add_u32 s61, s61, 1
    s_cmp_eq_u32 s61, 7
    s_cselect_b32 s61, 0, s61
    s_lshl_b32 s29, s61, 7
    buffer_load_ushort v19, v27, s[52:55], s29 offen
    s_add_u32 s61, s61, 1
    s_cmp_eq_u32 s61, 7
    s_cselect_b32 s61, 0, s61
    s_lshl_b32 s29, s61, 7
    buffer_load_ushort v20, v27, s[52:55], s29 offen
    s_add_u32 s61, s61, 1
    s_cmp_eq_u32 s61, 7
    s_cselect_b32 s61, 0, s61
    s_lshl_b32 s29, s61, 7
    buffer_load_ushort v21, v27, s[52:55], s29 offen
    s_add_u32 s61, s61, 1
    s_cmp_eq_u32 s61, 7
    s_cselect_b32 s61, 0, s61
    s_waitcnt vmcnt(22)
    s_add_u32 m0, s73, 30720
    s_add_u32 s72, s20, 100352
    buffer_load_dwordx4 v2, s[36:39], s72 offen  lds
    s_lshl_b32 s29, s61, 7
    buffer_load_ushort v22, v27, s[52:55], s29 offen
    s_add_u32 s61, s61, 1
    s_cmp_eq_u32 s61, 7
    s_cselect_b32 s61, 0, s61
    s_mul_i32 s29, s101, 2097152
    s_add_u32 s29, s29, 0
    s_add_u32 s56, s22, s29
    s_addc_u32 s57, s23, 0
    s_mov_b32 s58, 1835008
    s_mov_b32 s59, 0x20000
    s_waitcnt vmcnt(23)
    s_add_u32 m0, s73, 81920
    s_nop 0
    buffer_load_dwordx4 v3, s[40:43], s21 offen  lds
    s_lshl_b32 s29, s26, 2
    s_sub_u32 s29, s29, 8
    s_mul_i32 s69, s29, 28672
    s_mul_i32 s30, s25, 7
    s_lshr_b32 s30, s30, 1
    s_lshl_b32 s30, s30, 9
    s_waitcnt vmcnt(23)
    s_add_u32 m0, s73, 83968
    s_add_u32 s72, s21, 43008
    buffer_load_dwordx4 v3, s[40:43], s72 offen  lds
    s_add_u32 s30, s30, s69
    v_add_u32_e64 v6, s30, v1
    s_mul_i32 s30, s25, 448
    s_add_u32 s30, s30, s69
    v_lshrrev_b32 v24, 5, v0
    v_mul_u32_u24 v24, 7168, v24
    s_waitcnt vmcnt(23)
    s_add_u32 m0, s73, 86016
    s_add_u32 s72, s21, 86016
    buffer_load_dwordx4 v3, s[40:43], s72 offen  lds
    v_bfe_u32 v25, v0, 4, 1
    v_bfe_u32 v26, v0, 2, 1
    v_lshl_add_u32 v25, v25, 1, v26
    v_mul_u32_u24 v25, 7, v25
    v_bfe_u32 v26, v0, 3, 1
    v_lshl_add_u32 v25, v26, 2, v25
    s_waitcnt vmcnt(23)
    s_add_u32 m0, s73, 88064
    s_add_u32 s72, s21, 129024
    buffer_load_dwordx4 v3, s[40:43], s72 offen  lds
    v_and_b32 v26, 3, v0
    v_add_u32_e64 v25, v25, v26
    v_lshl_add_u32 v24, v25, 4, v24
    v_add_u32 v7, s30, v24
    s_mul_i32 s29, s25, 28
    s_add_u32 s30, s29, 27
    s_waitcnt vmcnt(23)
    s_add_u32 m0, s73, 90112
    s_add_u32 s72, s21, 896
    buffer_load_dwordx4 v3, s[40:43], s72 offen  lds
    s_lshr_b32 s29, s29, 6
    s_lshr_b32 s30, s30, 6
    s_cmp_eq_u32 s29, s30
    s_cselect_b32 s70, 0x15, 63
    s_min_u32 s29, s26, 2
    s_lshl_b32 s29, s29, 1
    s_sub_u32 s29, 4, s29
    s_lshl_b32 s30, -1, s29
    s_waitcnt vmcnt(23)
    s_add_u32 m0, s73, 92160
    s_add_u32 s72, s21, 43904
    buffer_load_dwordx4 v3, s[40:43], s72 offen  lds
    s_and_b32 s70, s70, s30
    s_mov_b32 s71, 0
    s_and_b32 s29, s26, 3
    s_lshl_b32 s29, s29, 3
    s_and_b32 s30, s25, 7
    s_add_u32 s100, s29, s30
    s_cmp_ge_u32 s100, 14
    s_cselect_b32 s29, 14, 0
    s_cselect_b32 s30, 1, 0
    s_sub_u32 s29, s100, s29
    s_lshr_b32 s10, s29, 1
    s_and_b32 s29, s29, 1
    s_lshr_b32 s31, s25, 3
    s_lshl_b32 s31, s31, 1
    s_add_u32 s30, s30, s31
    s_and_b32 s31, s26, 12
    s_add_u32 s30, s30, s31
    s_lshl_b32 s30, s30, 1
    s_add_u32 s30, s30, s29
    s_lshl_b32 s11, s30, 1
    s_lshl_b32 s29, s101, 2
    s_add_u32 s29, s29, 158720
    v_mov_b32 v9, s29
    v_lshrrev_b32 v14, 5, v0
    v_add_u32_e64 v14, -1, v14
    s_mov_b32 s66, 0x358637bd
    s_mov_b32 s67, 0x3fb8aa3b
    s_lshl_b32 s29, s26, 2
    s_add_u32 s29, s29, s101
    s_lshl_b32 s29, s29, 4
    s_add_u32 s29, s29, s25
    s_lshr_b32 s30, s29, 3
    s_lshl_b32 s30, s30, 5
    s_and_b32 s31, s25, 7
    s_add_u32 s30, s30, s31
    s_lshl_b32 s30, s30, 2
    s_add_u32 s62, s30, 11272192
    s_lshl_b32 s29, s29, 11
    s_add_u32 s68, s29, 6291456
    s_lshr_b32 s75, s101, 1
    s_and_b32 s64, s101, 1
    s_add_u32 s65, s11, s64
    s_waitcnt vmcnt(23)
    s_add_u32 m0, s73, 94208
    s_add_u32 s72, s21, 86912
    buffer_load_dwordx4 v3, s[40:43], s72 offen  lds
    v_bfe_u32 v243, v0, 2, 2
    v_bfe_u32 v240, v0, 4, 1
    v_and_b32_e64 v244, 3, v0
    v_lshl_add_u32 v244, v240, 2, v244
    v_lshlrev_b32_e64 v244, 3, v244
    s_mul_i32 s29, s75, 21504
    s_waitcnt vmcnt(23)
    s_add_u32 m0, s73, 96256
    s_add_u32 s72, s21, 129920
    buffer_load_dwordx4 v3, s[40:43], s72 offen  lds
    s_add_u32 s29, s29, 65536
    v_add_u32 v244, s29, v244
    v_lshrrev_b32 v242, 5, v0
    v_mul_u32_u24 v242, 7, v242
    v_min_u32_e64 v240, 3, v243
    v_add3_u32 v240, v240, v242, 0
    s_waitcnt vmcnt(23)
    ds_add_u32 v12, v11 offset:0
    s_add_u32 s60, s60, 1
    s_cmp_eq_u32 s60, 7
    s_cselect_b32 s60, 0, s60
    s_lshl_b32 s20, s60, 7
    s_mul_i32 s21, s60, 172032
    s_add_u32 m0, s73, 32768
    s_nop 0
    buffer_load_dwordx4 v2, s[36:39], s20 offen  lds
    v_bfe_u32 v241, v240, 1, 1
    v_xor_b32_e64 v241, s75, v241
    v_lshl_add_u32 v248, v240, 7, v244
    v_lshl_add_u32 v248, v241, 6, v248
    v_min_u32_e64 v240, 2, v243
    v_add3_u32 v240, v240, v242, 4
    s_waitcnt vmcnt(23)
    s_add_u32 m0, s73, 34816
    s_add_u32 s72, s20, 14336
    buffer_load_dwordx4 v2, s[36:39], s72 offen  lds
    v_bfe_u32 v241, v240, 1, 1
    v_xor_b32 v241, s75, v241
    v_lshl_add_u32 v249, v240, 7, v244
    v_lshl_add_u32 v249, v241, 6, v249
    v_min_u32_e64 v240, 3, v243
    v_add3_u32 v240, v240, v242, 14
    s_waitcnt vmcnt(23)
    s_add_u32 m0, s73, 36864
    s_add_u32 s72, s20, 28672
    buffer_load_dwordx4 v2, s[36:39], s72 offen  lds
    v_bfe_u32 v241, v240, 1, 1
    v_xor_b32 v241, s75, v241
    v_lshl_add_u32 v250, v240, 7, v244
    v_lshl_add_u32 v250, v241, 6, v250
    v_min_u32_e64 v240, 2, v243
    v_add3_u32 v240, v240, v242, 18
    s_waitcnt vmcnt(23)
    s_add_u32 m0, s73, 38912
    s_add_u32 s72, s20, 43008
    buffer_load_dwordx4 v2, s[36:39], s72 offen  lds
    v_bfe_u32 v241, v240, 1, 1
    v_xor_b32 v241, s75, v241
    v_lshl_add_u32 v251, v240, 7, v244
    v_lshl_add_u32 v251, v241, 6, v251
    s_lshl_b32 s29, s65, 1
    s_add_u32 s29, s29, s75
    s_waitcnt vmcnt(23)
    s_add_u32 m0, s73, 40960
    s_add_u32 s72, s20, 57344
    buffer_load_dwordx4 v2, s[36:39], s72 offen  lds
    s_lshl_b32 s63, s29, 7
    s_lshl_b32 s29, s29, 14
    v_add_u32 v252, s29, v1
    v_lshrrev_b32_e64 v24, 3, v0
    s_mul_i32 s29, s101, 224
    v_add_u32 v25, s29, v24
    s_waitcnt vmcnt(23)
    s_add_u32 m0, s73, 43008
    s_add_u32 s72, s20, 71680
    buffer_load_dwordx4 v2, s[36:39], s72 offen  lds
    v_mul_u32_u24 v8, 896, v25
    v_bfe_u32 v25, v0, 2, 1
    v_bfe_u32 v26, v0, 4, 1
    v_xor_b32_e64 v25, v25, v26
    v_lshl_add_u32 v8, v25, 6, v8
    v_and_b32 v26, 3, v0
    s_waitcnt vmcnt(23)
    s_add_u32 m0, s73, 45056
    s_add_u32 s72, s20, 86016
    buffer_load_dwordx4 v2, s[36:39], s72 offen  lds
    v_lshl_add_u32 v8, v26, 4, v8
    s_lshl_b32 s29, s10, 7
    v_add_u32_e64 v8, s29, v8
    s_waitcnt vmcnt(23)
    s_add_u32 m0, s73, 47104
    s_add_u32 s72, s20, 100352
    buffer_load_dwordx4 v2, s[36:39], s72 offen  lds
    s_waitcnt vmcnt(17)
    s_add_u32 m0, s73, 98304
    s_nop 0
    buffer_load_dwordx4 v3, s[40:43], s21 offen  lds
    s_waitcnt vmcnt(16)
    s_add_u32 m0, s73, 100352
    s_add_u32 s72, s21, 43008
    buffer_load_dwordx4 v3, s[40:43], s72 offen  lds
    s_waitcnt vmcnt(16)
    s_add_u32 m0, s73, 102400
    s_add_u32 s72, s21, 86016
    buffer_load_dwordx4 v3, s[40:43], s72 offen  lds
    s_waitcnt vmcnt(16)
    s_add_u32 m0, s73, 104448
    s_add_u32 s72, s21, 129024
    buffer_load_dwordx4 v3, s[40:43], s72 offen  lds
    s_waitcnt vmcnt(16)
    s_add_u32 m0, s73, 106496
    s_add_u32 s72, s21, 896
    buffer_load_dwordx4 v3, s[40:43], s72 offen  lds
    s_waitcnt vmcnt(16)
    s_add_u32 m0, s73, 108544
    s_add_u32 s72, s21, 43904
    buffer_load_dwordx4 v3, s[40:43], s72 offen  lds
    s_waitcnt vmcnt(16)
    s_add_u32 m0, s73, 110592
    s_add_u32 s72, s21, 86912
    buffer_load_dwordx4 v3, s[40:43], s72 offen  lds
    s_waitcnt vmcnt(16)
    s_add_u32 m0, s73, 112640
    s_add_u32 s72, s21, 129920
    buffer_load_dwordx4 v3, s[40:43], s72 offen  lds
    s_waitcnt vmcnt(16)
    ds_add_u32 v12, v11 offset:4
    s_add_u32 s60, s60, 1
    s_cmp_eq_u32 s60, 7
    s_cselect_b32 s60, 0, s60
    s_lshl_b32 s20, s60, 7
    s_mul_i32 s21, s60, 172032
    s_add_u32 m0, s73, 49152
    s_nop 0
    buffer_load_dwordx4 v2, s[36:39], s20 offen  lds
    s_waitcnt vmcnt(16)
    s_add_u32 m0, s73, 51200
    s_add_u32 s72, s20, 14336
    buffer_load_dwordx4 v2, s[36:39], s72 offen  lds
    s_waitcnt vmcnt(16)
    s_add_u32 m0, s73, 53248
    s_add_u32 s72, s20, 28672
    buffer_load_dwordx4 v2, s[36:39], s72 offen  lds
    s_waitcnt vmcnt(16)
    s_add_u32 m0, s73, 55296
    s_add_u32 s72, s20, 43008
    buffer_load_dwordx4 v2, s[36:39], s72 offen  lds
    s_waitcnt vmcnt(16)
    s_add_u32 m0, s73, 57344
    s_add_u32 s72, s20, 57344
    buffer_load_dwordx4 v2, s[36:39], s72 offen  lds
    s_waitcnt vmcnt(16)
    s_add_u32 m0, s73, 59392
    s_add_u32 s72, s20, 71680
    buffer_load_dwordx4 v2, s[36:39], s72 offen  lds
    s_waitcnt vmcnt(16)
    s_add_u32 m0, s73, 61440
    s_add_u32 s72, s20, 86016
    buffer_load_dwordx4 v2, s[36:39], s72 offen  lds
    s_waitcnt vmcnt(16)
    s_add_u32 m0, s73, 63488
    s_add_u32 s72, s20, 100352
    buffer_load_dwordx4 v2, s[36:39], s72 offen  lds
    s_waitcnt vmcnt(16)
    s_add_u32 m0, s73, 114688
    s_nop 0
    buffer_load_dwordx4 v3, s[40:43], s21 offen  lds
    s_waitcnt vmcnt(16)
    s_add_u32 m0, s73, 116736
    s_add_u32 s72, s21, 43008
    buffer_load_dwordx4 v3, s[40:43], s72 offen  lds
    s_waitcnt vmcnt(16)
    s_add_u32 m0, s73, 118784
    s_add_u32 s72, s21, 86016
    buffer_load_dwordx4 v3, s[40:43], s72 offen  lds
    s_waitcnt vmcnt(16)
    s_add_u32 m0, s73, 120832
    s_add_u32 s72, s21, 129024
    buffer_load_dwordx4 v3, s[40:43], s72 offen  lds
    s_waitcnt vmcnt(16)
    s_add_u32 m0, s73, 122880
    s_add_u32 s72, s21, 896
    buffer_load_dwordx4 v3, s[40:43], s72 offen  lds
    s_waitcnt vmcnt(16)
    s_add_u32 m0, s73, 124928
    s_add_u32 s72, s21, 43904
    buffer_load_dwordx4 v3, s[40:43], s72 offen  lds
    s_waitcnt vmcnt(16)
    s_add_u32 m0, s73, 126976
    s_add_u32 s72, s21, 86912
    buffer_load_dwordx4 v3, s[40:43], s72 offen  lds
    s_waitcnt vmcnt(16)
    s_add_u32 m0, s73, 129024
    s_add_u32 s72, s21, 129920
    buffer_load_dwordx4 v3, s[40:43], s72 offen  lds
    s_waitcnt vmcnt(16)
    ds_add_u32 v12, v11 offset:8
    s_waitcnt lgkmcnt(0)
    s_mov_b32 s3, 0
L_sp_3:
    ds_read_b128 v[28:31], v10 offset:0
    s_add_u32 s3, s3, 1
    s_cmp_gt_u32 s3, 60000
    s_cbranch_scc1 L_abort
    s_waitcnt lgkmcnt(0)
    v_min3_u32 v28, v28, v29, v30
    v_min_u32 v28, v28, v31
    v_cmp_le_u32 vcc, 1, v28
    s_cbranch_vccnz L_spx_4
    s_sleep 1
    s_branch L_sp_3
L_spx_4:
    s_add_u32 s60, s60, 1
    s_cmp_eq_u32 s60, 7
    s_cselect_b32 s60, 0, s60
    s_lshl_b32 s20, s60, 7
    s_mul_i32 s21, s60, 172032
    s_add_u32 m0, s73, 0
    s_nop 0
    buffer_load_dwordx4 v2, s[36:39], s20 offen  lds
    s_waitcnt vmcnt(16)
    s_add_u32 m0, s73, 2048
    s_add_u32 s72, s20, 14336
    buffer_load_dwordx4 v2, s[36:39], s72 offen  lds
    s_waitcnt vmcnt(16)
    s_add_u32 m0, s73, 4096
    s_add_u32 s72, s20, 28672
    buffer_load_dwordx4 v2, s[36:39], s72 offen  lds
    s_waitcnt vmcnt(16)
    s_add_u32 m0, s73, 6144
    s_add_u32 s72, s20, 43008
    buffer_load_dwordx4 v2, s[36:39], s72 offen  lds
    s_waitcnt vmcnt(16)
    s_add_u32 m0, s73, 8192
    s_add_u32 s72, s20, 57344
    buffer_load_dwordx4 v2, s[36:39], s72 offen  lds
    s_waitcnt vmcnt(16)
    s_add_u32 m0, s73, 10240
    s_add_u32 s72, s20, 71680
    buffer_load_dwordx4 v2, s[36:39], s72 offen  lds
    s_waitcnt vmcnt(16)
    s_add_u32 m0, s73, 12288
    s_add_u32 s72, s20, 86016
    buffer_load_dwordx4 v2, s[36:39], s72 offen  lds
    s_waitcnt vmcnt(16)
    s_add_u32 m0, s73, 14336
    s_add_u32 s72, s20, 100352
    buffer_load_dwordx4 v2, s[36:39], s72 offen  lds
    s_waitcnt vmcnt(16)
    s_add_u32 m0, s73, 65536
    s_nop 0
    buffer_load_dwordx4 v3, s[40:43], s21 offen  lds
    s_waitcnt vmcnt(16)
    s_add_u32 m0, s73, 67584
    s_add_u32 s72, s21, 43008
    buffer_load_dwordx4 v3, s[40:43], s72 offen  lds
    s_waitcnt vmcnt(16)
    s_add_u32 m0, s73, 69632
    s_add_u32 s72, s21, 86016
    buffer_load_dwordx4 v3, s[40:43], s72 offen  lds
    s_waitcnt vmcnt(16)
    s_add_u32 m0, s73, 71680
    s_add_u32 s72, s21, 129024
    buffer_load_dwordx4 v3, s[40:43], s72 offen  lds
    s_waitcnt vmcnt(16)
    s_add_u32 m0, s73, 73728
    s_add_u32 s72, s21, 896
    buffer_load_dwordx4 v3, s[40:43], s72 offen  lds
    s_waitcnt vmcnt(16)
    s_add_u32 m0, s73, 75776
    s_add_u32 s72, s21, 43904
    buffer_load_dwordx4 v3, s[40:43], s72 offen  lds
    s_waitcnt vmcnt(16)
    s_add_u32 m0, s73, 77824
    s_add_u32 s72, s21, 86912
    buffer_load_dwordx4 v3, s[40:43], s72 offen  lds
    s_waitcnt vmcnt(16)
    s_add_u32 m0, s73, 79872
    s_add_u32 s72, s21, 129920
    buffer_load_dwordx4 v3, s[40:43], s72 offen  lds
    s_waitcnt vmcnt(16)
    ds_add_u32 v12, v11 offset:12
    s_waitcnt lgkmcnt(0)
    s_mov_b32 s3, 0
L_sp_5:
    ds_read_b128 v[28:31], v10 offset:0
    s_add_u32 s3, s3, 1
    s_cmp_gt_u32 s3, 60000
    s_cbranch_scc1 L_abort
    s_waitcnt lgkmcnt(0)
    v_min3_u32 v28, v28, v29, v30
    v_min_u32_e64 v28, v28, v31
    v_cmp_le_u32 vcc, 2, v28
    s_cbranch_vccnz L_spx_6
    s_sleep 1
    s_branch L_sp_5
L_spx_6:
    s_add_u32 s60, s60, 1
    s_cmp_eq_u32 s60, 7
    s_cselect_b32 s60, 0, s60
    s_lshl_b32 s20, s60, 7
    s_mul_i32 s21, s60, 172032
    s_add_u32 m0, s73, 16384
    s_nop 0
    buffer_load_dwordx4 v2, s[36:39], s20 offen  lds
    s_waitcnt vmcnt(16)
    s_add_u32 m0, s73, 18432
    s_add_u32 s72, s20, 14336
    buffer_load_dwordx4 v2, s[36:39], s72 offen  lds
    s_waitcnt vmcnt(16)
    s_add_u32 m0, s73, 20480
    s_add_u32 s72, s20, 28672
    buffer_load_dwordx4 v2, s[36:39], s72 offen  lds
    s_waitcnt vmcnt(16)
    s_add_u32 m0, s73, 22528
    s_add_u32 s72, s20, 43008
    buffer_load_dwordx4 v2, s[36:39], s72 offen  lds
    s_waitcnt vmcnt(16)
    s_add_u32 m0, s73, 24576
    s_add_u32 s72, s20, 57344
    buffer_load_dwordx4 v2, s[36:39], s72 offen  lds
    s_waitcnt vmcnt(16)
    s_add_u32 m0, s73, 26624
    s_add_u32 s72, s20, 71680
    buffer_load_dwordx4 v2, s[36:39], s72 offen  lds
    s_waitcnt vmcnt(16)
    s_add_u32 m0, s73, 28672
    s_add_u32 s72, s20, 86016
    buffer_load_dwordx4 v2, s[36:39], s72 offen  lds
    s_waitcnt vmcnt(16)
    s_add_u32 m0, s73, 30720
    s_add_u32 s72, s20, 100352
    buffer_load_dwordx4 v2, s[36:39], s72 offen  lds
    s_waitcnt vmcnt(16)
    s_add_u32 m0, s73, 81920
    s_nop 0
    buffer_load_dwordx4 v3, s[40:43], s21 offen  lds
    s_waitcnt vmcnt(16)
    s_add_u32 m0, s73, 83968
    s_add_u32 s72, s21, 43008
    buffer_load_dwordx4 v3, s[40:43], s72 offen  lds
    s_waitcnt vmcnt(16)
    s_add_u32 m0, s73, 86016
    s_add_u32 s72, s21, 86016
    buffer_load_dwordx4 v3, s[40:43], s72 offen  lds
    s_waitcnt vmcnt(16)
    s_add_u32 m0, s73, 88064
    s_add_u32 s72, s21, 129024
    buffer_load_dwordx4 v3, s[40:43], s72 offen  lds
    s_waitcnt vmcnt(16)
    s_add_u32 m0, s73, 90112
    s_add_u32 s72, s21, 896
    buffer_load_dwordx4 v3, s[40:43], s72 offen  lds
    s_waitcnt vmcnt(16)
    s_add_u32 m0, s73, 92160
    s_add_u32 s72, s21, 43904
    buffer_load_dwordx4 v3, s[40:43], s72 offen  lds
    s_waitcnt vmcnt(16)
    s_add_u32 m0, s73, 94208
    s_add_u32 s72, s21, 86912
    buffer_load_dwordx4 v3, s[40:43], s72 offen  lds
    s_waitcnt vmcnt(16)
    s_add_u32 m0, s73, 96256
    s_add_u32 s72, s21, 129920
    buffer_load_dwordx4 v3, s[40:43], s72 offen  lds
    s_waitcnt vmcnt(16)
    ds_add_u32 v12, v11 offset:16
    s_waitcnt lgkmcnt(0)
    s_mov_b32 s3, 0
L_sp_7:
    ds_read_b128 v[28:31], v10 offset:0
    s_add_u32 s3, s3, 1
    s_cmp_gt_u32 s3, 60000
    s_cbranch_scc1 L_abort
    s_waitcnt lgkmcnt(0)
    v_min3_u32 v28, v28, v29, v30
    v_min_u32 v28, v28, v31
    v_cmp_le_u32 vcc, 3, v28
    s_cbranch_vccnz L_spx_8
    s_sleep 1
    s_branch L_sp_7
L_spx_8:
    s_add_u32 s60, s60, 1
    s_cmp_eq_u32 s60, 7
    s_cselect_b32 s60, 0, s60
    s_lshl_b32 s20, s60, 7
    s_mul_i32 s21, s60, 172032
    s_add_u32 m0, s73, 32768
    s_nop 0
    buffer_load_dwordx4 v2, s[36:39], s20 offen  lds
    s_waitcnt vmcnt(16)
    s_add_u32 m0, s73, 34816
    s_add_u32 s72, s20, 14336
    buffer_load_dwordx4 v2, s[36:39], s72 offen  lds
    s_waitcnt vmcnt(16)
    s_add_u32 m0, s73, 36864
    s_add_u32 s72, s20, 28672
    buffer_load_dwordx4 v2, s[36:39], s72 offen  lds
    s_waitcnt vmcnt(16)
    s_add_u32 m0, s73, 38912
    s_add_u32 s72, s20, 43008
    buffer_load_dwordx4 v2, s[36:39], s72 offen  lds
    s_waitcnt vmcnt(16)
    s_add_u32 m0, s73, 40960
    s_add_u32 s72, s20, 57344
    buffer_load_dwordx4 v2, s[36:39], s72 offen  lds
    s_waitcnt vmcnt(16)
    s_add_u32 m0, s73, 43008
    s_add_u32 s72, s20, 71680
    buffer_load_dwordx4 v2, s[36:39], s72 offen  lds
    s_waitcnt vmcnt(16)
    s_add_u32 m0, s73, 45056
    s_add_u32 s72, s20, 86016
    buffer_load_dwordx4 v2, s[36:39], s72 offen  lds
    s_waitcnt vmcnt(16)
    s_add_u32 m0, s73, 47104
    s_add_u32 s72, s20, 100352
    buffer_load_dwordx4 v2, s[36:39], s72 offen  lds
    s_waitcnt vmcnt(16)
    s_add_u32 m0, s73, 98304
    s_nop 0
    buffer_load_dwordx4 v3, s[40:43], s21 offen  lds
    s_waitcnt vmcnt(16)
    s_add_u32 m0, s73, 100352
    s_add_u32 s72, s21, 43008
    buffer_load_dwordx4 v3, s[40:43], s72 offen  lds
    s_waitcnt vmcnt(16)
    s_add_u32 m0, s73, 102400
    s_add_u32 s72, s21, 86016
    buffer_load_dwordx4 v3, s[40:43], s72 offen  lds
    s_waitcnt vmcnt(16)
    s_add_u32 m0, s73, 104448
    s_add_u32 s72, s21, 129024
    buffer_load_dwordx4 v3, s[40:43], s72 offen  lds
    s_waitcnt vmcnt(16)
    s_add_u32 m0, s73, 106496
    s_add_u32 s72, s21, 896
    buffer_load_dwordx4 v3, s[40:43], s72 offen  lds
    s_waitcnt vmcnt(16)
    s_add_u32 m0, s73, 108544
    s_add_u32 s72, s21, 43904
    buffer_load_dwordx4 v3, s[40:43], s72 offen  lds
    s_waitcnt vmcnt(16)
    s_add_u32 m0, s73, 110592
    s_add_u32 s72, s21, 86912
    buffer_load_dwordx4 v3, s[40:43], s72 offen  lds
    s_waitcnt vmcnt(16)
    s_add_u32 m0, s73, 112640
    s_add_u32 s72, s21, 129920
    buffer_load_dwordx4 v3, s[40:43], s72 offen  lds
    s_waitcnt vmcnt(16)
    ds_add_u32 v12, v11 offset:20
    s_add_u32 s60, s60, 1
    s_cmp_eq_u32 s60, 7
    s_cselect_b32 s60, 0, s60
    s_mul_i32 s21, s60, 172032
    s_add_u32 m0, s73, 131072
    s_nop 0
    buffer_load_dwordx4 v4, s[44:47], s21 offen  lds
    s_waitcnt vmcnt(8)
    s_add_u32 m0, s73, 133120
    s_add_u32 s72, s21, 86016
    buffer_load_dwordx4 v4, s[44:47], s72 offen  lds
    s_waitcnt vmcnt(8)
    s_add_u32 s60, s60, 1
    s_cmp_eq_u32 s60, 7
    s_cselect_b32 s60, 0, s60
    s_mul_i32 s21, s60, 172032
    s_add_u32 m0, s73, 135168
    s_nop 0
    buffer_load_dwordx4 v4, s[44:47], s21 offen  lds
    s_waitcnt vmcnt(8)
    s_add_u32 m0, s73, 137216
    s_add_u32 s72, s21, 86016
    buffer_load_dwordx4 v4, s[44:47], s72 offen  lds
    s_waitcnt vmcnt(8)
    s_add_u32 s60, s60, 1
    s_cmp_eq_u32 s60, 7
    s_cselect_b32 s60, 0, s60
    s_mul_i32 s21, s60, 172032
    s_add_u32 m0, s73, 139264
    s_nop 0
    buffer_load_dwordx4 v4, s[44:47], s21 offen  lds
    s_waitcnt vmcnt(8)
    s_add_u32 m0, s73, 141312
    s_add_u32 s72, s21, 86016
    buffer_load_dwordx4 v4, s[44:47], s72 offen  lds
    s_waitcnt vmcnt(8)
    s_add_u32 s60, s60, 1
    s_cmp_eq_u32 s60, 7
    s_cselect_b32 s60, 0, s60
    s_mul_i32 s21, s60, 172032
    s_add_u32 m0, s73, 143360
    s_nop 0
    buffer_load_dwordx4 v4, s[44:47], s21 offen  lds
    s_waitcnt vmcnt(8)
    s_add_u32 m0, s73, 145408
    s_add_u32 s72, s21, 86016
    buffer_load_dwordx4 v4, s[44:47], s72 offen  lds
    s_waitcnt vmcnt(8)
    ds_add_u32 v12, v11 offset:24
    s_add_u32 s60, s60, 1
    s_cmp_eq_u32 s60, 7
    s_cselect_b32 s60, 0, s60
    s_mul_i32 s21, s60, 172032
    s_add_u32 m0, s73, 147456
    s_nop 0
    buffer_load_dwordx4 v4, s[44:47], s21 offen  lds
    s_waitcnt vmcnt(8)
    s_add_u32 m0, s73, 149504
    s_add_u32 s72, s21, 86016
    buffer_load_dwordx4 v4, s[44:47], s72 offen  lds
    s_waitcnt vmcnt(8)
    ds_write_b16 v5, v16 offset:16384
    ds_add_u32 v12, v11 offset:28
    s_add_u32 s60, s60, 1
    s_cmp_eq_u32 s60, 7
    s_cselect_b32 s60, 0, s60
    s_mul_i32 s21, s60, 172032
    s_add_u32 m0, s73, 151552
    s_nop 0
    buffer_load_dwordx4 v4, s[44:47], s21 offen  lds
    s_waitcnt vmcnt(8)
    s_add_u32 m0, s73, 153600
    s_add_u32 s72, s21, 86016
    buffer_load_dwordx4 v4, s[44:47], s72 offen  lds
    s_waitcnt vmcnt(8)
    ds_write_b16 v5, v17 offset:20480
    ds_add_u32 v12, v11 offset:32
    s_waitcnt lgkmcnt(0)
    s_mov_b32 s3, 0
L_sp_9:
    ds_read_b128 v[28:31], v10 offset:0
    s_add_u32 s3, s3, 1
    s_cmp_gt_u32 s3, 60000
    s_cbranch_scc1 L_abort
    s_waitcnt lgkmcnt(0)
    v_min3_u32 v28, v28, v29, v30
    v_min_u32_e64 v28, v28, v31
    v_cmp_le_u32 vcc, 4, v28
    s_cbranch_vccnz L_spx_10
    s_sleep 1
    s_branch L_sp_9
L_spx_10:
    s_add_u32 s60, s60, 1
    s_cmp_eq_u32 s60, 7
    s_cselect_b32 s60, 0, s60
    s_mul_i32 s21, s60, 172032
    s_add_u32 m0, s73, 114688
    s_nop 0
    buffer_load_dwordx4 v4, s[44:47], s21 offen  lds
    s_waitcnt vmcnt(8)
    s_add_u32 m0, s73, 116736
    s_add_u32 s72, s21, 86016
    buffer_load_dwordx4 v4, s[44:47], s72 offen  lds
    s_waitcnt vmcnt(8)
    ds_write_b16 v5, v18 offset:24576
    ds_add_u32 v12, v11 offset:36
    s_cmp_eq_u32 s74, 0
    s_cbranch_scc0 L_lhold
    s_add_u32 s60, s60, 1
    s_cmp_eq_u32 s60, 7
    s_cselect_b32 s60, 0, s60
    s_mul_i32 s21, s60, 172032
    s_add_u32 m0, s73, 118784
    s_nop 0
    buffer_load_dwordx4 v4, s[48:51], s21 offen  lds
    s_waitcnt vmcnt(8)
    s_add_u32 m0, s73, 120832
    s_add_u32 s72, s21, 86016
    buffer_load_dwordx4 v4, s[48:51], s72 offen  lds
    s_waitcnt vmcnt(8)
    ds_write_b16 v5, v19 offset:28672
    ds_add_u32 v12, v11 offset:40
    s_add_u32 s60, s60, 1
    s_cmp_eq_u32 s60, 7
    s_cselect_b32 s60, 0, s60
    s_mul_i32 s21, s60, 172032
    s_add_u32 m0, s73, 122880
    s_nop 0
    buffer_load_dwordx4 v4, s[48:51], s21 offen  lds
    s_waitcnt vmcnt(8)
    s_add_u32 m0, s73, 124928
    s_add_u32 s72, s21, 86016
    buffer_load_dwordx4 v4, s[48:51], s72 offen  lds
    s_waitcnt vmcnt(8)
    ds_write_b16 v5, v20 offset:32768
    ds_add_u32 v12, v11 offset:44
    s_add_u32 s60, s60, 1
    s_cmp_eq_u32 s60, 7
    s_cselect_b32 s60, 0, s60
    s_mul_i32 s21, s60, 172032
    s_add_u32 m0, s73, 126976
    s_nop 0
    buffer_load_dwordx4 v4, s[48:51], s21 offen  lds
    s_waitcnt vmcnt(8)
    s_add_u32 m0, s73, 129024
    s_add_u32 s72, s21, 86016
    buffer_load_dwordx4 v4, s[48:51], s72 offen  lds
    s_waitcnt vmcnt(8)
    ds_write_b16 v5, v21 offset:36864
    ds_add_u32 v12, v11 offset:48
    s_add_u32 s60, s60, 1
    s_cmp_eq_u32 s60, 7
    s_cselect_b32 s60, 0, s60
    s_mul_i32 s21, s60, 172032
    s_add_u32 m0, s73, 49152
    s_nop 0
    buffer_load_dwordx4 v4, s[48:51], s21 offen  lds
    s_waitcnt vmcnt(8)
    s_add_u32 m0, s73, 51200
    s_add_u32 s72, s21, 86016
    buffer_load_dwordx4 v4, s[48:51], s72 offen  lds
    s_waitcnt vmcnt(8)
    ds_write_b16 v5, v22 offset:0
    ds_add_u32 v12, v11 offset:52
    s_add_u32 s60, s60, 1
    s_cmp_eq_u32 s60, 7
    s_cselect_b32 s60, 0, s60
    s_mul_i32 s21, s60, 172032
    s_add_u32 m0, s73, 53248
    s_nop 0
    buffer_load_dwordx4 v4, s[48:51], s21 offen  lds
    s_waitcnt vmcnt(8)
    s_add_u32 m0, s73, 55296
    s_add_u32 s72, s21, 86016
    buffer_load_dwordx4 v4, s[48:51], s72 offen  lds
    s_waitcnt vmcnt(8)
    ds_add_u32 v12, v11 offset:56
    s_add_u32 s60, s60, 1
    s_cmp_eq_u32 s60, 7
    s_cselect_b32 s60, 0, s60
    s_mul_i32 s21, s60, 172032
    s_add_u32 m0, s73, 57344
    s_nop 0
    buffer_load_dwordx4 v4, s[48:51], s21 offen  lds
    s_waitcnt vmcnt(8)
    s_add_u32 m0, s73, 59392
    s_add_u32 s72, s21, 86016
    buffer_load_dwordx4 v4, s[48:51], s72 offen  lds
    s_waitcnt vmcnt(8)
    ds_add_u32 v12, v11 offset:60
    s_add_u32 s60, s60, 1
    s_cmp_eq_u32 s60, 7
    s_cselect_b32 s60, 0, s60
    s_mul_i32 s21, s60, 172032
    s_add_u32 m0, s73, 61440
    s_nop 0
    buffer_load_dwordx4 v4, s[48:51], s21 offen  lds
    s_waitcnt vmcnt(8)
    s_add_u32 m0, s73, 63488
    s_add_u32 s72, s21, 86016
    buffer_load_dwordx4 v4, s[48:51], s72 offen  lds
    s_waitcnt vmcnt(8)
    ds_add_u32 v12, v11 offset:64
    s_waitcnt vmcnt(6)
    ds_add_u32 v12, v11 offset:68
    s_waitcnt vmcnt(4)
    ds_add_u32 v12, v11 offset:72
    s_waitcnt vmcnt(2)
    ds_add_u32 v12, v11 offset:76
    s_waitcnt vmcnt(0)
    ds_add_u32 v12, v11 offset:80
    s_waitcnt lgkmcnt(0)
    s_mov_b32 s3, 0
L_sp_1:
    ds_read_b32 v15, v10 offset:208
    s_add_u32 s3, s3, 1
    s_cmp_gt_u32 s3, 60000
    s_cbranch_scc1 L_abort
    s_waitcnt lgkmcnt(0)
    v_cmp_le_u32 vcc, 1, v15
    s_cbranch_vccnz L_spx_2
    s_sleep 1
    s_branch L_sp_1
L_spx_2:
    v_readfirstlane_b32 s2, v15
    s_lshl_b32 s69, s26, 4
    s_add_u32 s69, s69, s25
    s_lshl_b32 s69, s69, 7
    s_mul_i32 s30, s101, 32768
    s_add_u32 s69, s69, s30
    s_add_u32 s69, s69, 10747904
    v_lshlrev_b32 v32, 2, v0
    s_andn2_b32 s29, 63, s70
    s_cbranch_scc0 L_lnf
    s_mov_b32 exec_lo, s29
    s_mov_b32 exec_hi, 0
    buffer_store_dword v15, v32, s[32:35], s69 offen sc1
    s_mov_b64 exec, -1
L_lnf:
    s_branch L_ljoin
L_lhold:
    s_waitcnt vmcnt(6)
    ds_write_b16 v5, v19 offset:28672
    ds_add_u32 v12, v11 offset:40
    s_waitcnt vmcnt(4)
    ds_write_b16 v5, v20 offset:32768
    ds_add_u32 v12, v11 offset:44
    s_waitcnt vmcnt(2)
    ds_write_b16 v5, v21 offset:36864
    ds_add_u32 v12, v11 offset:48
    s_waitcnt vmcnt(0)
    ds_write_b16 v5, v22 offset:0
    ds_add_u32 v12, v11 offset:52
    s_waitcnt lgkmcnt(0)
    s_mov_b32 s3, 0
L_zsp_1:
    ds_read_b32 v15, v10 offset:208
    s_add_u32 s3, s3, 1
    s_cmp_gt_u32 s3, 60000
    s_cbranch_scc1 L_abort
    s_waitcnt lgkmcnt(0)
    v_cmp_le_u32 vcc, 1, v15
    s_cbranch_vccnz L_zspx_2
    s_sleep 1
    s_branch L_zsp_1
L_zspx_2:
    v_readfirstlane_b32 s2, v15
    s_lshl_b32 s69, s26, 4
    s_add_u32 s69, s69, s25
    s_lshl_b32 s69, s69, 7
    s_mul_i32 s30, s101, 32768
    s_add_u32 s69, s69, s30
    s_add_u32 s69, s69, 10747904
    v_lshlrev_b32_e64 v32, 2, v0
    s_andn2_b32 s29, 63, s70
    s_cbranch_scc0 L_lnf2
    s_mov_b32 exec_lo, s29
    s_mov_b32 exec_hi, 0
    buffer_store_dword v15, v32, s[32:35], s69 offen sc1
    s_mov_b64 exec, -1
L_lnf2:
    s_waitcnt lgkmcnt(0)
    s_mov_b32 s3, 0
L_sp_11:
    ds_read_b128 v[28:31], v10 offset:240
    s_add_u32 s3, s3, 1
    s_cmp_gt_u32 s3, 60000
    s_cbranch_scc1 L_abort
    s_waitcnt lgkmcnt(0)
    v_min3_u32 v28, v28, v29, v30
    v_min_u32 v28, v28, v31
    v_cmp_le_u32 vcc, 1, v28
    s_cbranch_vccnz L_spx_12
    s_sleep 1
    s_branch L_sp_11
L_spx_12:
    s_add_u32 s60, s60, 1
    s_cmp_eq_u32 s60, 7
    s_cselect_b32 s60, 0, s60
    s_mul_i32 s21, s60, 172032
    s_add_u32 m0, s73, 118784
    s_nop 0
    buffer_load_dwordx4 v4, s[48:51], s21 offen  lds
    s_add_u32 m0, s73, 120832
    s_add_u32 s72, s21, 86016
    buffer_load_dwordx4 v4, s[48:51], s72 offen  lds
    s_add_u32 s60, s60, 1
    s_cmp_eq_u32 s60, 7
    s_cselect_b32 s60, 0, s60
    s_mul_i32 s21, s60, 172032
    s_add_u32 m0, s73, 122880
    s_nop 0
    buffer_load_dwordx4 v4, s[48:51], s21 offen  lds
    s_add_u32 m0, s73, 124928
    s_add_u32 s72, s21, 86016
    buffer_load_dwordx4 v4, s[48:51], s72 offen  lds
    s_add_u32 s60, s60, 1
    s_cmp_eq_u32 s60, 7
    s_cselect_b32 s60, 0, s60
    s_mul_i32 s21, s60, 172032
    s_add_u32 m0, s73, 126976
    s_nop 0
    buffer_load_dwordx4 v4, s[48:51], s21 offen  lds
    s_add_u32 m0, s73, 129024
    s_add_u32 s72, s21, 86016
    buffer_load_dwordx4 v4, s[48:51], s72 offen  lds
    s_add_u32 s60, s60, 1
    s_cmp_eq_u32 s60, 7
    s_cselect_b32 s60, 0, s60
    s_mul_i32 s21, s60, 172032
    s_add_u32 m0, s73, 49152
    s_nop 0
    buffer_load_dwordx4 v4, s[48:51], s21 offen  lds
    s_add_u32 m0, s73, 51200
    s_add_u32 s72, s21, 86016
    buffer_load_dwordx4 v4, s[48:51], s72 offen  lds
    s_add_u32 s60, s60, 1
    s_cmp_eq_u32 s60, 7
    s_cselect_b32 s60, 0, s60
    s_mul_i32 s21, s60, 172032
    s_add_u32 m0, s73, 53248
    s_nop 0
    buffer_load_dwordx4 v4, s[48:51], s21 offen  lds
    s_add_u32 m0, s73, 55296
    s_add_u32 s72, s21, 86016
    buffer_load_dwordx4 v4, s[48:51], s72 offen  lds
    s_add_u32 s60, s60, 1
    s_cmp_eq_u32 s60, 7
    s_cselect_b32 s60, 0, s60
    s_mul_i32 s21, s60, 172032
    s_add_u32 m0, s73, 57344
    s_nop 0
    buffer_load_dwordx4 v4, s[48:51], s21 offen  lds
    s_add_u32 m0, s73, 59392
    s_add_u32 s72, s21, 86016
    buffer_load_dwordx4 v4, s[48:51], s72 offen  lds
    s_add_u32 s60, s60, 1
    s_cmp_eq_u32 s60, 7
    s_cselect_b32 s60, 0, s60
    s_mul_i32 s21, s60, 172032
    s_add_u32 m0, s73, 61440
    s_nop 0
    buffer_load_dwordx4 v4, s[48:51], s21 offen  lds
    s_add_u32 m0, s73, 63488
    s_add_u32 s72, s21, 86016
    buffer_load_dwordx4 v4, s[48:51], s72 offen  lds
    s_waitcnt vmcnt(12)
    ds_add_u32 v12, v11 offset:56
    s_waitcnt vmcnt(10)
    ds_add_u32 v12, v11 offset:60
    s_waitcnt vmcnt(8)
    ds_add_u32 v12, v11 offset:64
    s_waitcnt vmcnt(6)
    ds_add_u32 v12, v11 offset:68
    s_waitcnt vmcnt(4)
    ds_add_u32 v12, v11 offset:72
    s_waitcnt vmcnt(2)
    ds_add_u32 v12, v11 offset:76
    s_waitcnt vmcnt(0)
    ds_add_u32 v12, v11 offset:80
L_ljoin:
    s_mov_b32 s38, 401408
    s_mov_b32 s53, 7168
    s_mov_b32 s52, 0
    s_cmp_eq_u32 s101, 0
    s_cbranch_scc0 L_lgV
    s_waitcnt lgkmcnt(0)
    s_mov_b32 s3, 0
L_sp_13:
    ds_read_b128 v[28:31], v10 offset:32
    s_add_u32 s3, s3, 1
    s_cmp_gt_u32 s3, 60000
    s_cbranch_scc1 L_abort
    s_waitcnt lgkmcnt(0)
    v_min3_u32 v28, v28, v29, v30
    v_min_u32_e64 v28, v28, v31
    v_cmp_le_u32 vcc, 1, v28
    s_cbranch_vccnz L_spx_14
    s_sleep 1
    s_branch L_sp_13
L_spx_14:
    s_waitcnt lgkmcnt(0)
    s_mov_b32 s3, 0
L_sp_15:
    ds_read_b64 v[28:29], v10 offset:136
    s_add_u32 s3, s3, 1
    s_cmp_gt_u32 s3, 60000
    s_cbranch_scc1 L_abort
    s_waitcnt lgkmcnt(0)
    v_min_u32_e64 v28, v28, v29
    v_cmp_le_u32 vcc, 2, v28
    s_cbranch_vccnz L_spx_16
    s_sleep 1
    s_branch L_sp_15
L_spx_16:
    s_branch L_lg
L_lgV:
    s_waitcnt lgkmcnt(0)
    s_mov_b32 s3, 0
L_sp_17:
    ds_read_b128 v[28:31], v10 offset:144
    s_add_u32 s3, s3, 1
    s_cmp_gt_u32 s3, 60000
    s_cbranch_scc1 L_abort
    s_waitcnt lgkmcnt(0)
    v_min3_u32 v28, v28, v29, v30
    v_min_u32 v28, v28, v31
    v_cmp_le_u32 vcc, 1, v28
    s_cbranch_vccnz L_spx_18
    s_sleep 1
    s_branch L_sp_17
L_spx_18:
L_lg:
    s_add_u32 s42, s32, s69
    s_addc_u32 s43, s33, 0
    s_waitcnt lgkmcnt(0)
    s_mov_b32 s3, 0
L_sq_19:
    s_load_dwordx8 s[44:51], s[42:43], 0 glc
    s_add_u32 s3, s3, 1
    s_cmp_gt_u32 s3, 60000
    s_cbranch_scc1 L_abort
    s_waitcnt lgkmcnt(0)
    s_xor_b32 s44, s44, s2
    s_xor_b32 s45, s45, s2
    s_or_b32 s44, s44, s45
    s_xor_b32 s46, s46, s2
    s_or_b32 s44, s44, s46
    s_xor_b32 s47, s47, s2
    s_or_b32 s44, s44, s47
    s_xor_b32 s48, s48, s2
    s_or_b32 s44, s44, s48
    s_xor_b32 s49, s49, s2
    s_or_b32 s44, s44, s49
    s_cbranch_scc0 L_sqx_20
    s_sleep 1
    s_branch L_sq_19
L_sqx_20:
    s_cmp_eq_u32 s101, 0
    s_cbranch_scc0 L_lV
    s_mov_b32 m0, 16384
    s_nop 0
    buffer_load_dwordx4 v6, s[56:59], 0 offen offset:0 sc1 lds
    buffer_load_dwordx4 v6, s[56:59], 0 offen offset:1024 sc1 lds
    s_mov_b32 m0, 18432
    v_add_u32 v6, 28672, v6
    buffer_load_dwordx4 v6, s[56:59], 0 offen offset:0 sc1 lds
    buffer_load_dwordx4 v6, s[56:59], 0 offen offset:1024 sc1 lds
    s_mov_b32 m0, 20480
    v_add_u32 v6, 28672, v6
    buffer_load_dwordx4 v6, s[56:59], 0 offen offset:0 sc1 lds
    buffer_load_dwordx4 v6, s[56:59], 0 offen offset:1024 sc1 lds
    s_mov_b32 m0, 22528
    v_add_u32 v6, 28672, v6
    buffer_load_dwordx4 v6, s[56:59], 0 offen offset:0 sc1 lds
    buffer_load_dwordx4 v6, s[56:59], 0 offen offset:1024 sc1 lds
    s_mov_b32 m0, 24576
    v_add_u32 v6, 28672, v6
    buffer_load_dwordx4 v6, s[56:59], 0 offen offset:0 sc1 lds
    buffer_load_dwordx4 v6, s[56:59], 0 offen offset:1024 sc1 lds
    s_mov_b32 m0, 26624
    v_add_u32 v6, 28672, v6
    buffer_load_dwordx4 v6, s[56:59], 0 offen offset:0 sc1 lds
    buffer_load_dwordx4 v6, s[56:59], 0 offen offset:1024 sc1 lds
    s_mov_b32 m0, 28672
    v_add_u32 v6, 28672, v6
    buffer_load_dwordx4 v6, s[56:59], 0 offen offset:0 sc1 lds
    buffer_load_dwordx4 v6, s[56:59], 0 offen offset:1024 sc1 lds
    s_mov_b32 m0, 30720
    v_add_u32 v6, 28672, v6
    buffer_load_dwordx4 v6, s[56:59], 0 offen offset:0 sc1 lds
    buffer_load_dwordx4 v6, s[56:59], 0 offen offset:1024 sc1 lds
    s_mov_b32 m0, 32768
    v_add_u32 v6, 28672, v6
    buffer_load_dwordx4 v6, s[56:59], 0 offen offset:0 sc1 lds
    buffer_load_dwordx4 v6, s[56:59], 0 offen offset:1024 sc1 lds
    s_mov_b32 m0, 34816
    v_add_u32 v6, 28672, v6
    buffer_load_dwordx4 v6, s[56:59], 0 offen offset:0 sc1 lds
    buffer_load_dwordx4 v6, s[56:59], 0 offen offset:1024 sc1 lds
    s_mov_b32 m0, 36864
    v_add_u32 v6, 28672, v6
    buffer_load_dwordx4 v6, s[56:59], 0 offen offset:0 sc1 lds
    buffer_load_dwordx4 v6, s[56:59], 0 offen offset:1024 sc1 lds
    s_mov_b32 m0, 38912
    v_add_u32 v6, 28672, v6
    buffer_load_dwordx4 v6, s[56:59], 0 offen offset:0 sc1 lds
    buffer_load_dwordx4 v6, s[56:59], 0 offen offset:1024 sc1 lds
    s_mov_b32 s69, 84
    s_branch L_lKV
L_lV:
    v_mov_b32 v36, 0x3f803f80
    v_mov_b32 v37, 0x3f803f80
    v_mov_b32 v38, 0x3f803f80
    v_mov_b32 v39, 0x3f803f80
    v_lshlrev_b32 v24, 9, v0
    v_add_u32 v24, 131568, v24
    s_mov_b32 exec_hi, 0xffff
    ds_write_b128 v24, v[36:39]
    s_mov_b64 exec, -1
    s_waitcnt lgkmcnt(0)
    s_mov_b32 s3, 0
L_sp_21:
    ds_read_b32 v28, v10 offset:224
    s_add_u32 s3, s3, 1
    s_cmp_gt_u32 s3, 60000
    s_cbranch_scc1 L_abort
    s_waitcnt lgkmcnt(0)
    v_cmp_le_u32 vcc, 1, v28
    s_cbranch_vccnz L_spx_22
    s_sleep 1
    s_branch L_sp_21
L_spx_22:
    s_mov_b32 exec_lo, 0x7fffffff
    s_mov_b32 exec_hi, 0x7fffffff
    s_mov_b32 s72, 14336
    s_mov_b32 m0, 131072
    v_add_u32_e64 v26, s72, v7
    buffer_load_dwordx4 v7, s[56:59], 0 offen sc1 lds
    s_addk_i32 m0, 1024
    v_add_u32 v7, 28672, v7
    buffer_load_dwordx4 v26, s[56:59], 0 offen sc1 lds
    s_mov_b32 m0, 133120
    v_add_u32 v26, s72, v7
    buffer_load_dwordx4 v7, s[56:59], 0 offen sc1 lds
    s_addk_i32 m0, 1024
    v_add_u32 v7, 28672, v7
    buffer_load_dwordx4 v26, s[56:59], 0 offen sc1 lds
    s_mov_b32 m0, 135168
    v_add_u32 v26, s72, v7
    buffer_load_dwordx4 v7, s[56:59], 0 offen sc1 lds
    s_addk_i32 m0, 1024
    v_add_u32 v7, 28672, v7
    buffer_load_dwordx4 v26, s[56:59], 0 offen sc1 lds
    s_mov_b32 m0, 137216
    v_add_u32 v26, s72, v7
    buffer_load_dwordx4 v7, s[56:59], 0 offen sc1 lds
    s_addk_i32 m0, 1024
    v_add_u32 v7, 28672, v7
    buffer_load_dwordx4 v26, s[56:59], 0 offen sc1 lds
    s_mov_b32 m0, 139264
    v_add_u32 v26, s72, v7
    buffer_load_dwordx4 v7, s[56:59], 0 offen sc1 lds
    s_addk_i32 m0, 1024
    v_add_u32 v7, 28672, v7
    buffer_load_dwordx4 v26, s[56:59], 0 offen sc1 lds
    s_mov_b32 m0, 141312
    v_add_u32 v26, s72, v7
    buffer_load_dwordx4 v7, s[56:59], 0 offen sc1 lds
    s_addk_i32 m0, 1024
    v_add_u32 v7, 28672, v7
    buffer_load_dwordx4 v26, s[56:59], 0 offen sc1 lds
    s_mov_b32 m0, 143360
    v_add_u32 v26, s72, v7
    buffer_load_dwordx4 v7, s[56:59], 0 offen sc1 lds
    s_addk_i32 m0, 1024
    v_add_u32 v7, 28672, v7
    buffer_load_dwordx4 v26, s[56:59], 0 offen sc1 lds
    s_mov_b32 m0, 145408
    v_add_u32 v26, s72, v7
    buffer_load_dwordx4 v7, s[56:59], 0 offen sc1 lds
    s_addk_i32 m0, 1024
    v_add_u32 v7, 28672, v7
    buffer_load_dwordx4 v26, s[56:59], 0 offen sc1 lds
    s_mov_b32 m0, 147456
    v_add_u32 v26, s72, v7
    buffer_load_dwordx4 v7, s[56:59], 0 offen sc1 lds
    s_addk_i32 m0, 1024
    v_add_u32 v7, 28672, v7
    buffer_load_dwordx4 v26, s[56:59], 0 offen sc1 lds
    s_mov_b32 m0, 149504
    v_add_u32 v26, s72, v7
    buffer_load_dwordx4 v7, s[56:59], 0 offen sc1 lds
    s_addk_i32 m0, 1024
    v_add_u32 v7, 28672, v7
    buffer_load_dwordx4 v26, s[56:59], 0 offen sc1 lds
    s_mov_b32 m0, 151552
    v_add_u32 v26, s72, v7
    buffer_load_dwordx4 v7, s[56:59], 0 offen sc1 lds
    s_addk_i32 m0, 1024
    v_add_u32 v7, 28672, v7
    buffer_load_dwordx4 v26, s[56:59], 0 offen sc1 lds
    s_mov_b32 m0, 153600
    v_add_u32 v26, s72, v7
    buffer_load_dwordx4 v7, s[56:59], 0 offen sc1 lds
    s_addk_i32 m0, 1024
    v_add_u32 v7, 28672, v7
    buffer_load_dwordx4 v26, s[56:59], 0 offen sc1 lds
    s_mov_b64 exec, -1
    s_mov_b32 s69, 88
L_lKV:
    ds_add_u32 v13, v11 offset:224
    s_cmp_ge_u32 s100, 28
    s_cbranch_scc0 L_lwo
    s_waitcnt vmcnt(0)
    v_add_u32 v26, s69, v12
    v_mov_b32_e64 v24, 2
    ds_add_u32 v26, v24
    s_waitcnt lgkmcnt(0)
    s_call_b64 s[54:55], L_sub_phi
L_lph2:
    s_call_b64 s[54:55], L_sub_ob
    s_endpgm
L_lwo:
    s_call_b64 s[54:55], L_sub_phi
    s_waitcnt vmcnt(0)
    v_add_u32 v26, s69, v12
    v_mov_b32 v24, 2
    ds_add_u32 v26, v24
    s_mul_i32 s29, s75, 4294952960
    s_sub_u32 s29, s29, 49152
    v_add_u32 v2, s29, v248
    v_add_u32 v3, s29, v249
    v_add_u32 v4, s29, v250
    v_add_u32 v5, s29, v251
    v_mov_b32_e64 v6, v252
    v_and_b32 v9, 0xffff0000, v15
    s_mov_b32 s60, 0
    s_setprio 0
    s_waitcnt lgkmcnt(0)
    s_mov_b32 s3, 0
L_ws_23:
    ds_read_b128 v[28:31], v10 offset:144
    ds_read_b32 v24, v10 offset:204
    s_add_u32 s3, s3, 1
    s_cmp_gt_u32 s3, 60000
    s_cbranch_scc1 L_abort
    s_waitcnt lgkmcnt(0)
    v_cmp_lt_u32 vcc, s60, v24
    s_cbranch_vccz L_ws1_24
    s_call_b64 s[54:55], L_sub_ob
    s_mov_b32 s60, 1
    s_mov_b32 s3, 0
    s_branch L_ws_23
L_ws1_24:
    v_min3_u32 v28, v28, v29, v30
    v_min_u32_e64 v28, v28, v31
    v_cmp_le_u32 vcc, 2, v28
    s_cbranch_vccnz L_ws2_25
    s_sleep 2
    s_branch L_ws_23
L_ws2_25:
    s_setprio 3
    s_mov_b32 s36, s14
    s_mov_b32 s37, s15
    s_mov_b32 s72, 150528
    s_mul_i32 s73, s101, 7168
    s_add_u32 m0, s73, 16384
    s_call_b64 s[54:55], L_sub_d7e
    s_setprio 0
    s_mov_b32 s3, 0
L_ws_26:
    ds_read_b128 v[28:31], v10 offset:176
    ds_read_b32 v24, v10 offset:204
    s_add_u32 s3, s3, 1
    s_cmp_gt_u32 s3, 60000
    s_cbranch_scc1 L_abort
    s_waitcnt lgkmcnt(0)
    v_cmp_lt_u32 vcc, s60, v24
    s_cbranch_vccz L_ws1_27
    s_call_b64 s[54:55], L_sub_ob
    s_mov_b32 s60, 1
    s_mov_b32 s3, 0
    s_branch L_ws_26
L_ws1_27:
    v_min3_u32 v28, v28, v29, v30
    v_min_u32 v28, v28, v31
    v_cmp_le_u32 vcc, 1, v28
    s_cbranch_vccnz L_ws2_28
    s_sleep 2
    s_branch L_ws_26
L_ws2_28:
    s_setprio 3
    s_mov_b32 s36, s8
    s_mov_b32 s37, s9
    s_mov_b32 s72, 150528
    s_mul_i32 s73, s101, 7168
    s_add_u32 m0, s73, 0
    s_call_b64 s[54:55], L_sub_d7e
    s_setprio 0
    s_mov_b32 s3, 0
L_ws_29:
    ds_read_b32 v28, v10 offset:348
    ds_read_b32 v24, v10 offset:204
    s_add_u32 s3, s3, 1
    s_cmp_gt_u32 s3, 60000
    s_cbranch_scc1 L_abort
    s_waitcnt lgkmcnt(0)
    v_cmp_lt_u32 vcc, s60, v24
    s_cbranch_vccz L_ws1_30
    s_call_b64 s[54:55], L_sub_ob
    s_mov_b32 s60, 1
    s_mov_b32 s3, 0
    s_branch L_ws_29
L_ws1_30:
    v_cmp_eq_u32 vcc, 2, v28
    s_cbranch_vccnz L_ws2_31
    s_sleep 2
    s_branch L_ws_29
L_ws2_31:
    s_setprio 3
    s_call_b64 s[54:55], L_sub_r0
    s_cmp_lg_u32 s60, 0
    s_cbranch_scc1 L_lt0
    s_call_b64 s[54:55], L_sub_ob
    s_mov_b32 s60, 1
    s_waitcnt vmcnt(3)
    s_branch L_lt1
L_lt0:
    s_waitcnt vmcnt(0)
L_lt1:
    ds_add_u32 v12, v11 offset:100
    ds_add_u32 v12, v11 offset:96
    s_branch L_p3
L_xwave:
    s_waitcnt lgkmcnt(0)
    s_mov_b32 s1, s2
    s_barrier
    s_mov_b32 s32, s22
    s_mov_b32 s33, s23
    s_mov_b32 s34, 16777216
    s_mov_b32 s35, 0x20000
    s_and_b32 s29, s26, 3
    s_lshl_b32 s29, s29, 3
    s_and_b32 s30, s25, 7
    s_add_u32 s100, s29, s30
    s_cmp_ge_u32 s100, 14
    s_cselect_b32 s29, 14, 0
    s_cselect_b32 s30, 1, 0
    s_sub_u32 s29, s100, s29
    s_lshr_b32 s10, s29, 1
    s_and_b32 s29, s29, 1
    s_lshr_b32 s31, s25, 3
    s_lshl_b32 s31, s31, 1
    s_add_u32 s30, s30, s31
    s_and_b32 s31, s26, 12
    s_add_u32 s30, s30, s31
    s_lshl_b32 s30, s30, 1
    s_add_u32 s30, s30, s29
    s_lshl_b32 s11, s30, 1
    s_lshl_b32 s29, s101, 2
    s_add_u32 s29, s29, 158720
    v_mov_b32 v9, s29
    v_lshrrev_b32 v14, 5, v0
    v_add_u32 v14, -1, v14
    s_mov_b32 s66, 0x358637bd
    s_mov_b32 s67, 0x3fb8aa3b
    s_lshl_b32 s29, s26, 2
    s_add_u32 s29, s29, s101
    s_lshl_b32 s29, s29, 4
    s_add_u32 s29, s29, s25
    s_lshr_b32 s30, s29, 3
    s_lshl_b32 s30, s30, 5
    s_and_b32 s31, s25, 7
    s_add_u32 s30, s30, s31
    s_lshl_b32 s30, s30, 2
    s_add_u32 s62, s30, 11272192
    s_lshl_b32 s29, s29, 11
    s_add_u32 s68, s29, 6291456
    s_lshr_b32 s75, s101, 1
    s_and_b32 s64, s101, 1
    s_add_u32 s65, s11, s64
    v_bfe_u32 v243, v0, 2, 2
    v_bfe_u32 v240, v0, 4, 1
    v_and_b32 v244, 3, v0
    v_lshl_add_u32 v244, v240, 2, v244
    v_lshlrev_b32_e64 v244, 3, v244
    s_mul_i32 s29, s75, 21504
    s_add_u32 s29, s29, 65536
    v_add_u32 v244, s29, v244
    v_lshrrev_b32 v242, 5, v0
    v_mul_u32_u24 v242, 7, v242
    v_min_u32 v240, 3, v243
    v_add3_u32 v240, v240, v242, 0
    v_bfe_u32 v241, v240, 1, 1
    v_xor_b32_e64 v241, s75, v241
    v_lshl_add_u32 v248, v240, 7, v244
    v_lshl_add_u32 v248, v241, 6, v248
    v_min_u32_e64 v240, 2, v243
    v_add3_u32 v240, v240, v242, 4
    v_bfe_u32 v241, v240, 1, 1
    v_xor_b32_e64 v241, s75, v241
    v_lshl_add_u32 v249, v240, 7, v244
    v_lshl_add_u32 v249, v241, 6, v249
    v_min_u32_e64 v240, 3, v243
    v_add3_u32 v240, v240, v242, 14
    v_bfe_u32 v241, v240, 1, 1
    v_xor_b32_e64 v241, s75, v241
    v_lshl_add_u32 v250, v240, 7, v244
    v_lshl_add_u32 v250, v241, 6, v250
    v_min_u32_e64 v240, 2, v243
    v_add3_u32 v240, v240, v242, 18
    v_bfe_u32 v241, v240, 1, 1
    v_xor_b32_e64 v241, s75, v241
    v_lshl_add_u32 v251, v240, 7, v244
    v_lshl_add_u32 v251, v241, 6, v251
    s_lshl_b32 s29, s65, 1
    s_add_u32 s29, s29, s75
    s_lshl_b32 s63, s29, 7
    s_lshl_b32 s29, s29, 14
    v_add_u32 v252, s29, v1
    v_lshrrev_b32 v24, 5, v0
    v_lshlrev_b32 v24, 2, v24
    v_and_b32_e64 v25, 31, v0
    v_sub_u32 v24, v25, v24
    v_mov_b32 v25, 0x3f80
    v_mov_b32 v26, 0x3f800000
    v_cmp_eq_u32 vcc, 0, v24
    s_nop 1
    v_cndmask_b32 v48, 0, v25, vcc
    v_cmp_eq_u32 vcc, 1, v24
    s_nop 1
    v_cndmask_b32 v48, v48, v26, vcc
    v_cmp_eq_u32 vcc, 2, v24
    s_nop 1
    v_cndmask_b32 v49, 0, v25, vcc
    v_cmp_eq_u32 vcc, 3, v24
    s_nop 1
    v_cndmask_b32 v49, v49, v26, vcc
    v_cmp_eq_u32 vcc, 8, v24
    s_nop 1
    v_cndmask_b32 v50, 0, v25, vcc
    v_cmp_eq_u32 vcc, 9, v24
    s_nop 1
    v_cndmask_b32 v50, v50, v26, vcc
    v_cmp_eq_u32 vcc, 10, v24
    s_nop 1
    v_cndmask_b32 v51, 0, v25, vcc
    v_cmp_eq_u32 vcc, 11, v24
    s_nop 1
    v_cndmask_b32 v51, v51, v26, vcc
    v_cmp_eq_u32 vcc, 16, v24
    s_nop 1
    v_cndmask_b32 v52, 0, v25, vcc
    v_cmp_eq_u32 vcc, 17, v24
    s_nop 1
    v_cndmask_b32 v52, v52, v26, vcc
    v_cmp_eq_u32 vcc, 18, v24
    s_nop 1
    v_cndmask_b32 v53, 0, v25, vcc
    v_cmp_eq_u32 vcc, 19, v24
    s_nop 1
    v_cndmask_b32 v53, v53, v26, vcc
    v_cmp_eq_u32 vcc, 24, v24
    s_nop 1
    v_cndmask_b32 v54, 0, v25, vcc
    v_cmp_eq_u32 vcc, 25, v24
    s_nop 1
    v_cndmask_b32 v54, v54, v26, vcc
    v_cmp_eq_u32 vcc, 26, v24
    s_nop 1
    v_cndmask_b32 v55, 0, v25, vcc
    v_cmp_eq_u32 vcc, 27, v24
    s_nop 1
    v_cndmask_b32 v55, v55, v26, vcc
    s_sub_u32 s73, s24, 6
    s_mov_b32 s36, s20
    s_mov_b32 s37, s21
    s_mov_b32 s38, 256
    s_mov_b32 s39, 0x20000
    s_mov_b32 s40, s22
    s_mov_b32 s41, s23
    s_mov_b32 s42, 16777216
    s_mov_b32 s43, 0x20000
    s_cmp_eq_u32 s25, 15
    s_cselect_b32 s42, 0, s42
    v_mov_b32_e64 v24, 0
    s_lshl_b32 s29, s2, 1
    s_add_u32 s29, s29, s73
    s_cmp_eq_u32 s29, 0
    s_cbranch_scc0 L_xnoep
    s_mov_b32 s29, 10813440
    buffer_load_dword v15, v24, s[32:35], s29 offen sc1
    s_waitcnt vmcnt(0)
    v_lshrrev_b32 v25, 16, v15
    v_add_u32_e64 v15, 1, v15
    v_and_b32 v15, 0xffff, v15
    v_max_u32 v15, 1, v15
    v_cmp_eq_u32 vcc, v15, v25
    s_nop 1
    v_addc_co_u32 v15, vcc, 0, v15, vcc
    v_and_b32 v15, 0xffff, v15
    v_max_u32_e64 v15, 1, v15
    v_lshl_or_b32 v15, v15, 16, v15
    s_mov_b64 exec, 1
    buffer_store_dword v15, v24, s[36:39], 0 offen sc1
    buffer_store_dword v15, v24, s[32:35], s29 offen sc1
    s_mov_b64 exec, -1
L_xnoep:
    s_waitcnt lgkmcnt(0)
    s_mov_b32 s3, 0
L_wl_32:
    ds_read_b32 v28, v10 offset:256
    s_add_u32 s3, s3, 1
    s_cmp_gt_u32 s3, 60000
    s_cbranch_scc1 L_abort
    s_waitcnt lgkmcnt(0)
    v_cmp_eq_u32 vcc, 2, v28
    s_cbranch_vccnz L_wlx_33
    s_sleep 1
    s_branch L_wl_32
L_wlx_33:
    s_cmp_eq_u32 s73, 0
    s_cselect_b32 s44, s8, s6
    s_cselect_b32 s45, s9, s7
    s_cselect_b32 s48, s14, s12
    s_cselect_b32 s49, s15, s13
    s_mov_b32 s29, 1204224
    s_cselect_b32 s46, 401408, s29
    s_mov_b32 s47, 0x20000
    s_mov_b32 s29, 2688
    s_cselect_b32 s30, 896, s29
    s_mov_b32 s50, s46
    s_mov_b32 s51, 0x20000
    s_mul_i32 s29, s2, 13
    v_add_u32_e64 v32, s29, v0
    v_mul_u32_u24 v33, 9363, v32
    v_lshrrev_b32 v33, 16, v33
    v_mul_u32_u24 v34, 7, v33
    v_sub_u32 v32, v32, v34
    v_mul_u32_u24 v33, s30, v33
    v_lshl_add_u32 v32, v32, 7, v33
    s_mov_b64 exec, 0x1fff
    buffer_load_dword v33, v32, s[44:47], 0 offen
    buffer_load_dword v34, v32, s[48:51], 0 offen
    s_mov_b64 exec, -1
    s_waitcnt lgkmcnt(0)
    s_mov_b32 s3, 0
L_wl_34:
    ds_read_b32 v28, v10 offset:264
    s_add_u32 s3, s3, 1
    s_cmp_gt_u32 s3, 60000
    s_cbranch_scc1 L_abort
    s_waitcnt lgkmcnt(0)
    v_cmp_eq_u32 vcc, 2, v28
    s_cbranch_vccnz L_wlx_35
    s_sleep 1
    s_branch L_wl_34
L_wlx_35:
    s_mov_b32 s3, 0
L_pv_36:
    buffer_load_dword v15, v24, s[36:39], 0 offen sc1
    s_add_u32 s3, s3, 1
    s_cmp_gt_u32 s3, 60000
    s_cbranch_scc1 L_abort
    s_waitcnt vmcnt(0)
    v_cmp_eq_u32 vcc, 0, v15
    s_cbranch_vccnz L_pv_36
    ds_write_b32 v10, v15 offset:208
    v_readfirstlane_b32 s2, v15
    s_mov_b32 s36, s14
    s_mov_b32 s37, s15
    s_mov_b32 s38, 401408
    s_mov_b32 s39, 0x20000
    s_mov_b32 s53, 7168
    s_mov_b32 s52, 0
    v_lshrrev_b32_e64 v24, 3, v0
    v_mul_u32_u24 v8, 896, v24
    v_bfe_u32 v25, v0, 2, 1
    v_bfe_u32 v26, v0, 4, 1
    v_xor_b32_e64 v25, v25, v26
    v_lshl_add_u32 v8, v25, 6, v8
    v_and_b32_e64 v26, 3, v0
    v_lshl_add_u32 v8, v26, 4, v8
    s_lshl_b32 s29, s10, 7
    v_add_u32 v8, s29, v8
    v_mov_b32_e64 v12, v13
    s_mov_b32 s29, 158976
    v_writelane_b32 v12, s29, 0
    s_setprio 3
    s_cmp_eq_u32 s74, 0
    s_cbranch_scc1 L_xY
    s_lshl_b32 s29, s28, 6
    s_mul_i32 s30, s29, 2341
    s_lshr_b32 s30, s30, 16
    s_add_u32 s29, s29, 63
    s_mul_i32 s31, s29, 2341
    s_lshr_b32 s31, s31, 16
    v_and_b32 v4, 3, v0
    v_add_u32 v4, s30, v4
    v_lshrrev_b32 v5, 2, v0
    v_cmp_ge_u32 s[48:49], s31, v4
    v_add_u32 v6, s26, v5
    v_cmp_gt_u32 vcc, 16, v6
    s_nop 0
    s_and_b64 s[48:49], s[48:49], vcc
    s_and_b32 s48, s48, 0xfff
    s_mov_b32 s49, 0
    s_cmp_eq_u32 s25, 15
    s_cselect_b32 s48, 0, s48
    v_lshl_add_u32 v3, v6, 4, v4
    v_lshlrev_b32 v3, 5, v3
    v_mul_u32_u24 v4, 28, v4
    v_lshrrev_b32 v4, 6, v4
    v_sub_u32 v4, s28, v4
    v_lshlrev_b32_e64 v5, 1, v5
    v_sub_u32 v5, 4, v5
    v_add3_u32 v3, v3, v4, v5
    v_lshlrev_b32_e64 v3, 2, v3
    s_mul_i32 s50, s73, 32768
    s_add_u32 s50, s50, 10747904
    s_mul_i32 s44, s26, 114688
    s_cmp_eq_u32 s73, 0
    s_cbranch_scc0 L_xZV
    ds_add_u32 v13, v11 offset:128
    ds_add_u32 v13, v11 offset:128
    s_waitcnt lgkmcnt(0)
    s_mov_b32 s3, 0
L_sp_37:
    ds_read_b128 v[28:31], v10 offset:64
    s_add_u32 s3, s3, 1
    s_cmp_gt_u32 s3, 60000
    s_cbranch_scc1 L_abort
    s_waitcnt lgkmcnt(0)
    v_min3_u32 v28, v28, v29, v30
    v_min_u32_e64 v28, v28, v31
    v_cmp_le_u32 vcc, 1, v28
    s_cbranch_vccnz L_spx_38
    s_sleep 1
    s_branch L_sp_37
L_spx_38:
    s_branch L_xZn
L_xZV:
    ds_add_u32 v13, v11 offset:128
    ds_add_u32 v13, v11 offset:128
    s_waitcnt lgkmcnt(0)
    s_mov_b32 s3, 0
L_sp_39:
    ds_read_b128 v[28:31], v10 offset:80
    s_add_u32 s3, s3, 1
    s_cmp_gt_u32 s3, 60000
    s_cbranch_scc1 L_abort
    s_waitcnt lgkmcnt(0)
    v_min3_u32 v28, v28, v29, v30
    v_min_u32 v28, v28, v31
    v_cmp_le_u32 vcc, 1, v28
    s_cbranch_vccnz L_spx_40
    s_sleep 1
    s_branch L_sp_39
L_spx_40:
L_xZn:
    s_cmp_eq_u32 s48, 0
    s_cbranch_scc1 L_nn_41
    s_waitcnt vmcnt(0)
    s_mov_b64 exec, s[48:49]
    buffer_store_dword v15, v3, s[32:35], s50 offen sc1
    s_mov_b64 exec, -1
L_nn_41:
    s_cmp_ge_u32 s100, 28
    s_cbranch_scc1 L_eb_42
    s_mul_i32 s72, s73, 200704
    s_mul_i32 s29, s73, 21504
    s_add_u32 m0, s29, 65536
    s_call_b64 s[54:55], L_sub_d7e
    s_call_b64 s[54:55], L_sub_d7e
    s_call_b64 s[54:55], L_sub_d7e
L_eb_42:
    s_cmp_eq_u32 s73, 1
    s_cbranch_scc1 L_w1z
    s_waitcnt vmcnt(0)
    ds_add_u32 v12, v11 offset:92
L_w1z:
    s_branch L_xjoin
L_xY:
    v_bfe_u32 v26, v0, 4, 1
    v_bfe_u32 v25, v0, 2, 1
    v_lshl_add_u32 v26, v26, 1, v25
    v_mul_u32_u24 v26, 7, v26
    v_bfe_u32 v25, v0, 3, 1
    v_lshl_add_u32 v26, v25, 2, v26
    v_and_b32 v25, 3, v0
    v_add_u32 v26, v26, v25
    v_lshrrev_b32 v25, 5, v0
    v_lshlrev_b32_e64 v25, 9, v25
    v_lshl_add_u32 v26, v26, 4, v25
    s_lshl_b32 s29, s73, 11
    v_add_u32 v25, s29, v1
    s_add_u32 s30, s29, 16384
    v_add_u32 v26, s30, v26
    v_lshrrev_b32 v2, 2, v0
    v_lshlrev_b32 v2, 12, v2
    v_and_b32 v3, 3, v0
    v_lshl_add_u32 v2, v3, 9, v2
    s_add_u32 s29, s29, 16832
    v_add_u32_e64 v2, s29, v2
    v_mov_b32 v32, 0x3f803f80
    v_mov_b32 v33, 0x3f803f80
    v_mov_b32 v34, 0x3f803f80
    v_mov_b32 v35, 0x3f803f80
    s_lshl_b32 s29, s28, 1
    s_add_u32 s29, s29, s73
    s_lshl_b32 s29, s29, 4
    s_add_u32 s29, s29, s26
    s_lshl_b32 s44, s29, 11
    s_add_u32 s44, s44, 8388608
    s_lshr_b32 s30, s29, 4
    s_lshl_b32 s30, s30, 5
    s_add_u32 s30, s30, s26
    s_lshl_b32 s46, s30, 2
    s_add_u32 s46, s46, 10878976
    s_waitcnt lgkmcnt(0)
    s_mov_b32 s3, 0
L_sp_43:
    ds_read_b128 v[28:31], v10 offset:80
    s_add_u32 s3, s3, 1
    s_cmp_gt_u32 s3, 60000
    s_cbranch_scc1 L_abort
    s_waitcnt lgkmcnt(0)
    v_min3_u32 v28, v28, v29, v30
    v_min_u32_e64 v28, v28, v31
    v_cmp_le_u32 vcc, 1, v28
    s_cbranch_vccnz L_spx_44
    s_sleep 1
    s_branch L_sp_43
L_spx_44:
    s_mov_b64 exec, 0xffff
    ds_write_b128 v2, v[32:35]
    s_mov_b64 exec, -1
    ds_read_b128 v[96:99], v26 offset:0
    ds_read_b128 v[100:103], v26 offset:1024
    ds_read_b128 v[104:107], v26 offset:4096
    ds_read_b128 v[108:111], v26 offset:5120
    ds_read_b128 v[112:115], v26 offset:8192
    ds_read_b128 v[116:119], v26 offset:9216
    ds_read_b128 v[120:123], v26 offset:12288
    ds_read_b128 v[124:127], v26 offset:13312
    ds_add_u32 v13, v11 offset:128
    v_mov_b32 v56, 0x35863586
    v_mov_b32 v57, 0x35863586
    v_mov_b32 v58, 0x35863586
    v_mov_b32 v59, 0x35863586
    s_waitcnt lgkmcnt(8)
    s_nop 0
    v_mfma_f32_32x32x16_bf16 v[32:47], v[56:59], v[96:99], 0
    s_waitcnt lgkmcnt(7)
    v_mfma_f32_32x32x16_bf16 v[32:47], v[56:59], v[100:103], v[32:47]
    s_waitcnt lgkmcnt(6)
    v_mfma_f32_32x32x16_bf16 v[32:47], v[56:59], v[104:107], v[32:47]
    s_waitcnt lgkmcnt(5)
    v_mfma_f32_32x32x16_bf16 v[32:47], v[56:59], v[108:111], v[32:47]
    s_waitcnt lgkmcnt(4)
    v_mfma_f32_32x32x16_bf16 v[32:47], v[56:59], v[112:115], v[32:47]
    s_waitcnt lgkmcnt(3)
    v_mfma_f32_32x32x16_bf16 v[32:47], v[56:59], v[116:119], v[32:47]
    s_waitcnt lgkmcnt(2)
    v_mfma_f32_32x32x16_bf16 v[32:47], v[56:59], v[120:123], v[32:47]
    s_waitcnt lgkmcnt(1)
    v_mfma_f32_32x32x16_bf16 v[32:47], v[56:59], v[124:127], v[32:47]
    s_waitcnt lgkmcnt(0)
    s_mov_b32 s3, 0
L_sp_45:
    ds_read_b128 v[28:31], v10 offset:64
    s_add_u32 s3, s3, 1
    s_cmp_gt_u32 s3, 60000
    s_cbranch_scc1 L_abort
    s_waitcnt lgkmcnt(0)
    v_min3_u32 v28, v28, v29, v30
    v_min_u32 v28, v28, v31
    v_cmp_le_u32 vcc, 1, v28
    s_cbranch_vccnz L_spx_46
    s_sleep 1
    s_branch L_sp_45
L_spx_46:
    ds_read_b128 v[64:67], v25 offset:32768
    ds_read_b128 v[68:71], v25 offset:33792
    ds_read_b128 v[72:75], v25 offset:36864
    ds_read_b128 v[76:79], v25 offset:37888
    ds_read_b128 v[80:83], v25 offset:40960
    ds_read_b128 v[84:87], v25 offset:41984
    ds_read_b128 v[88:91], v25 offset:45056
    ds_read_b128 v[92:95], v25 offset:46080
    ds_add_u32 v13, v11 offset:128
    s_waitcnt lgkmcnt(8)
    v_mfma_f32_32x32x16_bf16 v[32:47], v[64:67], v[96:99], v[32:47]
    s_waitcnt lgkmcnt(7)
    v_mfma_f32_32x32x16_bf16 v[32:47], v[68:71], v[100:103], v[32:47]
    s_waitcnt lgkmcnt(6)
    v_mfma_f32_32x32x16_bf16 v[32:47], v[72:75], v[104:107], v[32:47]
    s_waitcnt lgkmcnt(5)
    v_mfma_f32_32x32x16_bf16 v[32:47], v[76:79], v[108:111], v[32:47]
    s_waitcnt lgkmcnt(4)
    v_mfma_f32_32x32x16_bf16 v[32:47], v[80:83], v[112:115], v[32:47]
    s_waitcnt lgkmcnt(3)
    v_mfma_f32_32x32x16_bf16 v[32:47], v[84:87], v[116:119], v[32:47]
    s_waitcnt lgkmcnt(2)
    v_mfma_f32_32x32x16_bf16 v[32:47], v[88:91], v[120:123], v[32:47]
    s_waitcnt lgkmcnt(1)
    v_mfma_f32_32x32x16_bf16 v[32:47], v[92:95], v[124:127], v[32:47]
    s_nop 11
    v_cvt_pk_bf16_f32 v56, v32, v33
    v_cvt_pk_bf16_f32 v57, v34, v35
    v_cvt_pk_bf16_f32 v58, v36, v37
    v_cvt_pk_bf16_f32 v59, v38, v39
    v_cvt_pk_bf16_f32 v60, v40, v41
    v_cvt_pk_bf16_f32 v61, v42, v43
    v_cvt_pk_bf16_f32 v62, v44, v45
    v_cvt_pk_bf16_f32 v63, v46, v47
    buffer_store_dwordx4 v[56:59], v1, s[32:35], s44 offen offset:0 sc1
    buffer_store_dwordx4 v[60:63], v1, s[32:35], s44 offen offset:1024 sc1
    s_cmp_ge_u32 s100, 28
    s_cbranch_scc1 L_eb_47
    s_mul_i32 s72, s73, 200704
    s_mul_i32 s29, s73, 21504
    s_add_u32 m0, s29, 65536
    s_call_b64 s[54:55], L_sub_d7e
    s_call_b64 s[54:55], L_sub_d7e
    s_waitcnt vmcnt(14)
    v_lshlrev_b32 v24, 7, v0
    s_mov_b64 exec, 1
    buffer_store_dword v15, v24, s[32:35], s46 offen sc1
    s_mov_b64 exec, -1
    s_call_b64 s[54:55], L_sub_d7e
    s_cmp_eq_u32 s73, 1
    s_cbranch_scc1 L_w1n
    s_waitcnt vmcnt(0)
    ds_add_u32 v12, v11 offset:92
L_w1n:
    s_branch L_ye
L_eb_47:
    s_waitcnt vmcnt(0)
    v_lshlrev_b32_e64 v24, 7, v0
    s_mov_b64 exec, 1
    buffer_store_dword v15, v24, s[32:35], s46 offen sc1
    s_mov_b64 exec, -1
L_ye:
    s_nop 1
L_xjoin:
    s_setprio 3
    s_cmp_eq_u32 s73, 1
    s_cbranch_scc1 L_x1p
    s_cmp_ge_u32 s100, 28
    s_cbranch_scc1 L_xfin
    s_call_b64 s[54:55], L_sub_phi
    s_mul_i32 s29, s75, 4294952960
    s_sub_u32 s29, s29, 49152
    v_add_u32 v2, s29, v248
    v_add_u32 v3, s29, v249
    v_add_u32 v4, s29, v250
    v_add_u32 v5, s29, v251
    v_mov_b32_e64 v6, v252
    v_and_b32 v9, 0xffff0000, v15
    s_mov_b32 s60, 0
    s_setprio 0
    s_waitcnt lgkmcnt(0)
    s_mov_b32 s3, 0
L_sp_50:
    ds_read_b64 v[28:29], v10 offset:136
    s_add_u32 s3, s3, 1
    s_cmp_gt_u32 s3, 60000
    s_cbranch_scc1 L_abort
    s_waitcnt lgkmcnt(0)
    v_min_u32 v28, v28, v29
    v_cmp_le_u32 vcc, 2, v28
    s_cbranch_vccnz L_spx_51
    s_sleep 1
    s_branch L_sp_50
L_spx_51:
    s_setprio 3
    s_setprio 0
    s_waitcnt lgkmcnt(0)
    s_mov_b32 s3, 0
L_sp_52:
    ds_read_b128 v[28:31], v10 offset:48
    s_add_u32 s3, s3, 1
    s_cmp_gt_u32 s3, 60000
    s_cbranch_scc1 L_abort
    s_waitcnt lgkmcnt(0)
    v_min3_u32 v28, v28, v29, v30
    v_min_u32 v28, v28, v31
    v_cmp_le_u32 vcc, 1, v28
    s_cbranch_vccnz L_spx_53
    s_sleep 1
    s_branch L_sp_52
L_spx_53:
    s_setprio 3
    s_setprio 0
    s_waitcnt lgkmcnt(0)
    s_mov_b32 s3, 0
L_sp_54:
    ds_read_b64 v[28:29], v10 offset:224
    s_add_u32 s3, s3, 1
    s_cmp_gt_u32 s3, 60000
    s_cbranch_scc1 L_abort
    s_waitcnt lgkmcnt(0)
    v_min_u32 v28, v28, v29
    v_cmp_le_u32 vcc, 1, v28
    s_cbranch_vccnz L_spx_55
    s_sleep 1
    s_branch L_sp_54
L_spx_55:
    s_setprio 3
    s_mov_b32 s36, s8
    s_mov_b32 s37, s9
    s_mov_b32 s72, 0
    s_mov_b32 m0, 40960
    s_call_b64 s[54:55], L_sub_d7
    s_call_b64 s[54:55], L_sub_d7
    s_call_b64 s[54:55], L_sub_d7
    s_mov_b32 s36, s8
    s_mov_b32 s37, s9
    s_mov_b32 s72, 200704
    s_mov_b32 m0, 108544
    s_call_b64 s[54:55], L_sub_d7
    s_call_b64 s[54:55], L_sub_d7
    s_call_b64 s[54:55], L_sub_d7
    s_setprio 0
    s_waitcnt lgkmcnt(0)
    s_mov_b32 s3, 0
L_wl_48:
    ds_read_b32 v28, v10 offset:348
    s_add_u32 s3, s3, 1
    s_cmp_gt_u32 s3, 60000
    s_cbranch_scc1 L_abort
    s_waitcnt lgkmcnt(0)
    v_cmp_eq_u32 vcc, 2, v28
    s_cbranch_vccnz L_wlx_49
    s_sleep 1
    s_branch L_wl_48
L_wlx_49:
    s_setprio 3
    s_call_b64 s[54:55], L_sub_r0
    s_waitcnt vmcnt(0)
    ds_add_u32 v12, v11 offset:96
    s_branch L_p3
L_x1p:
    s_call_b64 s[54:55], L_sub_phi
    s_mul_i32 s29, s75, 4294952960
    s_sub_u32 s29, s29, 49152
    v_add_u32 v2, s29, v248
    v_add_u32 v3, s29, v249
    v_add_u32 v4, s29, v250
    v_add_u32 v5, s29, v251
    v_mov_b32 v6, v252
    v_and_b32 v9, 0xffff0000, v15
    s_mov_b32 s60, 0
    s_lshl_b32 s30, s25, 7
    s_add_u32 s30, s30, 10878976
    s_add_u32 s56, s32, s30
    s_addc_u32 s57, s33, 0
    s_waitcnt lgkmcnt(0)
    s_mov_b32 s3, 0
L_sq_57:
    s_load_dwordx16 s[36:51], s[56:57], 0 glc
    s_add_u32 s3, s3, 1
    s_cmp_gt_u32 s3, 60000
    s_cbranch_scc1 L_abort
    s_waitcnt lgkmcnt(0)
    s_xor_b32 s36, s36, s2
    s_xor_b32 s37, s37, s2
    s_or_b32 s36, s36, s37
    s_xor_b32 s38, s38, s2
    s_or_b32 s36, s36, s38
    s_xor_b32 s39, s39, s2
    s_or_b32 s36, s36, s39
    s_xor_b32 s40, s40, s2
    s_or_b32 s36, s36, s40
    s_xor_b32 s41, s41, s2
    s_or_b32 s36, s36, s41
    s_xor_b32 s42, s42, s2
    s_or_b32 s36, s36, s42
    s_xor_b32 s43, s43, s2
    s_or_b32 s36, s36, s43
    s_xor_b32 s44, s44, s2
    s_or_b32 s36, s36, s44
    s_xor_b32 s45, s45, s2
    s_or_b32 s36, s36, s45
    s_xor_b32 s46, s46, s2
    s_or_b32 s36, s36, s46
    s_xor_b32 s47, s47, s2
    s_or_b32 s36, s36, s47
    s_xor_b32 s48, s48, s2
    s_or_b32 s36, s36, s48
    s_xor_b32 s49, s49, s2
    s_or_b32 s36, s36, s49
    s_xor_b32 s50, s50, s2
    s_or_b32 s36, s36, s50
    s_xor_b32 s51, s51, s2
    s_or_b32 s36, s36, s51
    s_cbranch_scc0 L_sqx_58
    s_sleep 1
    s_branch L_sq_57
L_sqx_58:
    s_lshl_b32 s44, s25, 15
    s_add_u32 s44, s44, 8388608
    buffer_load_dwordx4 v[64:67], v1, s[32:35], s44 offen offset:0 sc1
    buffer_load_dwordx4 v[68:71], v1, s[32:35], s44 offen offset:1024 sc1
    buffer_load_dwordx4 v[72:75], v1, s[32:35], s44 offen offset:2048 sc1
    buffer_load_dwordx4 v[76:79], v1, s[32:35], s44 offen offset:3072 sc1
    s_add_u32 s44, s44, 4096
    buffer_load_dwordx4 v[80:83], v1, s[32:35], s44 offen offset:0 sc1
    buffer_load_dwordx4 v[84:87], v1, s[32:35], s44 offen offset:1024 sc1
    buffer_load_dwordx4 v[88:91], v1, s[32:35], s44 offen offset:2048 sc1
    buffer_load_dwordx4 v[92:95], v1, s[32:35], s44 offen offset:3072 sc1
    s_add_u32 s44, s44, 4096
    buffer_load_dwordx4 v[96:99], v1, s[32:35], s44 offen offset:0 sc1
    buffer_load_dwordx4 v[100:103], v1, s[32:35], s44 offen offset:1024 sc1
    buffer_load_dwordx4 v[104:107], v1, s[32:35], s44 offen offset:2048 sc1
    buffer_load_dwordx4 v[108:111], v1, s[32:35], s44 offen offset:3072 sc1
    s_add_u32 s44, s44, 4096
    buffer_load_dwordx4 v[112:115], v1, s[32:35], s44 offen offset:0 sc1
    buffer_load_dwordx4 v[116:119], v1, s[32:35], s44 offen offset:1024 sc1
    buffer_load_dwordx4 v[120:123], v1, s[32:35], s44 offen offset:2048 sc1
    buffer_load_dwordx4 v[124:127], v1, s[32:35], s44 offen offset:3072 sc1
    s_add_u32 s44, s44, 4096
    s_setprio 0
    s_waitcnt vmcnt(15)
    v_mfma_f32_32x32x16_bf16 v[32:47], v[48:51], v[64:67], 0
    ds_add_u32 v12, v11 offset:92
    buffer_load_dwordx4 v[64:67], v1, s[32:35], s44 offen offset:0 sc1
    s_waitcnt vmcnt(15)
    v_mfma_f32_32x32x16_bf16 v[32:47], v[52:55], v[68:71], v[32:47]
    buffer_load_dwordx4 v[68:71], v1, s[32:35], s44 offen offset:1024 sc1
    s_waitcnt vmcnt(15)
    v_mfma_f32_32x32x16_bf16 v[32:47], v[48:51], v[72:75], v[32:47]
    buffer_load_dwordx4 v[72:75], v1, s[32:35], s44 offen offset:2048 sc1
    s_waitcnt vmcnt(15)
    v_mfma_f32_32x32x16_bf16 v[32:47], v[52:55], v[76:79], v[32:47]
    buffer_load_dwordx4 v[76:79], v1, s[32:35], s44 offen offset:3072 sc1
    s_add_u32 s44, s44, 4096
    s_waitcnt vmcnt(15)
    v_mfma_f32_32x32x16_bf16 v[32:47], v[48:51], v[80:83], v[32:47]
    buffer_load_dwordx4 v[80:83], v1, s[32:35], s44 offen offset:0 sc1
    s_waitcnt vmcnt(15)
    v_mfma_f32_32x32x16_bf16 v[32:47], v[52:55], v[84:87], v[32:47]
    buffer_load_dwordx4 v[84:87], v1, s[32:35], s44 offen offset:1024 sc1
    s_waitcnt vmcnt(15)
    v_mfma_f32_32x32x16_bf16 v[32:47], v[48:51], v[88:91], v[32:47]
    buffer_load_dwordx4 v[88:91], v1, s[32:35], s44 offen offset:2048 sc1
    s_waitcnt vmcnt(15)
    v_mfma_f32_32x32x16_bf16 v[32:47], v[52:55], v[92:95], v[32:47]
    buffer_load_dwordx4 v[92:95], v1, s[32:35], s44 offen offset:3072 sc1
    s_add_u32 s44, s44, 4096
    s_waitcnt vmcnt(15)
    v_mfma_f32_32x32x16_bf16 v[32:47], v[48:51], v[96:99], v[32:47]
    buffer_load_dwordx4 v[96:99], v1, s[32:35], s44 offen offset:0 sc1
    s_waitcnt vmcnt(15)
    v_mfma_f32_32x32x16_bf16 v[32:47], v[52:55], v[100:103], v[32:47]
    buffer_load_dwordx4 v[100:103], v1, s[32:35], s44 offen offset:1024 sc1
    s_waitcnt vmcnt(15)
    v_mfma_f32_32x32x16_bf16 v[32:47], v[48:51], v[104:107], v[32:47]
    buffer_load_dwordx4 v[104:107], v1, s[32:35], s44 offen offset:2048 sc1
    s_waitcnt vmcnt(15)
    v_mfma_f32_32x32x16_bf16 v[32:47], v[52:55], v[108:111], v[32:47]
    buffer_load_dwordx4 v[108:111], v1, s[32:35], s44 offen offset:3072 sc1
    s_add_u32 s44, s44, 4096
    s_waitcnt vmcnt(15)
    v_mfma_f32_32x32x16_bf16 v[32:47], v[48:51], v[112:115], v[32:47]
    buffer_load_dwordx4 v[112:115], v1, s[32:35], s44 offen offset:0 sc1
    s_waitcnt vmcnt(15)
    v_mfma_f32_32x32x16_bf16 v[32:47], v[52:55], v[116:119], v[32:47]
    buffer_load_dwordx4 v[116:119], v1, s[32:35], s44 offen offset:1024 sc1
    s_waitcnt vmcnt(15)
    v_mfma_f32_32x32x16_bf16 v[32:47], v[48:51], v[120:123], v[32:47]
    buffer_load_dwordx4 v[120:123], v1, s[32:35], s44 offen offset:2048 sc1
    s_waitcnt vmcnt(15)
    v_mfma_f32_32x32x16_bf16 v[32:47], v[52:55], v[124:127], v[32:47]
    buffer_load_dwordx4 v[124:127], v1, s[32:35], s44 offen offset:3072 sc1
    s_add_u32 s44, s44, 4096
    s_waitcnt vmcnt(15)
    v_mfma_f32_32x32x16_bf16 v[32:47], v[48:51], v[64:67], v[32:47]
    s_waitcnt vmcnt(14)
    v_mfma_f32_32x32x16_bf16 v[32:47], v[52:55], v[68:71], v[32:47]
    s_waitcnt vmcnt(13)
    v_mfma_f32_32x32x16_bf16 v[32:47], v[48:51], v[72:75], v[32:47]
    s_waitcnt vmcnt(12)
    v_mfma_f32_32x32x16_bf16 v[32:47], v[52:55], v[76:79], v[32:47]
    s_waitcnt vmcnt(11)
    v_mfma_f32_32x32x16_bf16 v[32:47], v[48:51], v[80:83], v[32:47]
    s_waitcnt vmcnt(10)
    v_mfma_f32_32x32x16_bf16 v[32:47], v[52:55], v[84:87], v[32:47]
    s_waitcnt vmcnt(9)
    v_mfma_f32_32x32x16_bf16 v[32:47], v[48:51], v[88:91], v[32:47]
    s_waitcnt vmcnt(8)
    v_mfma_f32_32x32x16_bf16 v[32:47], v[52:55], v[92:95], v[32:47]
    s_waitcnt vmcnt(7)
    v_mfma_f32_32x32x16_bf16 v[32:47], v[48:51], v[96:99], v[32:47]
    s_waitcnt vmcnt(6)
    v_mfma_f32_32x32x16_bf16 v[32:47], v[52:55], v[100:103], v[32:47]
    s_waitcnt vmcnt(5)
    v_mfma_f32_32x32x16_bf16 v[32:47], v[48:51], v[104:107], v[32:47]
    s_waitcnt vmcnt(4)
    v_mfma_f32_32x32x16_bf16 v[32:47], v[52:55], v[108:111], v[32:47]
    s_waitcnt vmcnt(3)
    v_mfma_f32_32x32x16_bf16 v[32:47], v[48:51], v[112:115], v[32:47]
    s_waitcnt vmcnt(2)
    v_mfma_f32_32x32x16_bf16 v[32:47], v[52:55], v[116:119], v[32:47]
    s_waitcnt vmcnt(1)
    v_mfma_f32_32x32x16_bf16 v[32:47], v[48:51], v[120:123], v[32:47]
    s_waitcnt vmcnt(0)
    v_mfma_f32_32x32x16_bf16 v[32:47], v[52:55], v[124:127], v[32:47]
    s_setprio 3
    s_nop 10
    v_cvt_pk_bf16_f32 v96, v32, v33
    v_cvt_pk_bf16_f32 v97, v34, v35
    v_cvt_pk_bf16_f32 v98, v36, v37
    v_cvt_pk_bf16_f32 v99, v38, v39
    v_cvt_pk_bf16_f32 v100, v40, v41
    v_cvt_pk_bf16_f32 v101, v42, v43
    v_cvt_pk_bf16_f32 v102, v44, v45
    v_cvt_pk_bf16_f32 v103, v46, v47
    v_add_u32 v24, 161280, v1
    ds_write_b128 v24, v[96:99]
    ds_write_b128 v24, v[100:103] offset:1024
    ds_add_u32 v13, v11 offset:192
    s_waitcnt lgkmcnt(0)
    s_call_b64 s[54:55], L_sub_ob
    s_mov_b32 s60, 1
    s_cmp_ge_u32 s100, 28
    s_cbranch_scc1 L_xend
    s_setprio 0
    s_waitcnt lgkmcnt(0)
    s_mov_b32 s3, 0
L_wl_59:
    ds_read_b32 v28, v10 offset:348
    s_add_u32 s3, s3, 1
    s_cmp_gt_u32 s3, 60000
    s_cbranch_scc1 L_abort
    s_waitcnt lgkmcnt(0)
    v_cmp_eq_u32 vcc, 2, v28
    s_cbranch_vccnz L_wlx_60
    s_sleep 1
    s_branch L_wl_59
L_wlx_60:
    s_setprio 3
    s_call_b64 s[54:55], L_sub_r0
    s_branch L_p3
L_xfin:
    s_call_b64 s[54:55], L_sub_phi
    s_call_b64 s[54:55], L_sub_ob
L_xend:
    s_endpgm
L_p3:
    s_setprio 0
    s_mov_b32 s3, 0
L_ws_61:
    ds_read_b32 v28, v10 offset:356
    ds_read_b32 v24, v10 offset:204
    s_add_u32 s3, s3, 1
    s_cmp_gt_u32 s3, 60000
    s_cbranch_scc1 L_abort
    s_waitcnt lgkmcnt(0)
    v_cmp_lt_u32 vcc, s60, v24
    s_cbranch_vccz L_ws1_62
    s_call_b64 s[54:55], L_sub_ob
    s_mov_b32 s60, 1
    s_mov_b32 s3, 0
    s_branch L_ws_61
L_ws1_62:
    v_cmp_eq_u32 vcc, 2, v28
    s_cbranch_vccnz L_ws2_63
    s_sleep 2
    s_branch L_ws_61
L_ws2_63:
    s_setprio 3
    s_call_b64 s[54:55], L_sub_r1
    s_cmp_lg_u32 s60, 0
    s_cbranch_scc1 L_pB
    s_call_b64 s[54:55], L_sub_ob
L_pB:
    s_mov_b32 s58, 6291456
    s_add_u32 s59, s63, 11272192
L_sub_half:
    s_add_u32 s56, s32, s59
    s_addc_u32 s57, s33, 0
    s_waitcnt lgkmcnt(0)
    s_mov_b32 s3, 0
L_gr_64:
    s_load_dwordx8 s[44:51], s[56:57], 0 glc
    s_add_u32 s3, s3, 1
    s_cmp_gt_u32 s3, 60000
    s_cbranch_scc1 L_abort
    s_waitcnt lgkmcnt(0)
    s_xor_b32 s29, s44, s2
    s_xor_b32 s30, s45, s2
    s_or_b32 s29, s29, s30
    s_cbranch_scc1 L_gr_64
    s_add_u32 s31, s58, 0
    buffer_load_dwordx4 v[64:67], v6, s[32:35], s31 offen offset:0 sc1
    buffer_load_dwordx4 v[68:71], v6, s[32:35], s31 offen offset:1024 sc1
    buffer_load_dwordx4 v[72:75], v6, s[32:35], s31 offen offset:2048 sc1
    buffer_load_dwordx4 v[76:79], v6, s[32:35], s31 offen offset:3072 sc1
    s_xor_b32 s29, s46, s2
    s_xor_b32 s30, s47, s2
    s_or_b32 s29, s29, s30
    s_cbranch_scc1 L_grc_69
L_grx_68:
    s_add_u32 s31, s58, 4096
    buffer_load_dwordx4 v[80:83], v6, s[32:35], s31 offen offset:0 sc1
    buffer_load_dwordx4 v[84:87], v6, s[32:35], s31 offen offset:1024 sc1
    buffer_load_dwordx4 v[88:91], v6, s[32:35], s31 offen offset:2048 sc1
    buffer_load_dwordx4 v[92:95], v6, s[32:35], s31 offen offset:3072 sc1
L_half_mid:
    s_mov_b32 s40, s18
    s_mov_b32 s41, s19
    s_mov_b32 s42, 1835008
    s_mov_b32 s43, 0x20000
    s_mul_i32 s29, s24, 8704
    s_add_u32 s29, s29, 65536
    v_add_u32 v2, s29, v1
    s_lshr_b32 s30, s24, 2
    s_mul_i32 s29, s30, 8704
    s_add_u32 s29, s29, 65536
    s_and_b32 s31, s24, 3
    s_lshl_b32 s31, s31, 3
    v_lshrrev_b32 v5, 3, v0
    v_add_u32 v5, s31, v5
    v_lshl_add_u32 v3, v5, 4, s29
    v_and_b32_e64 v24, 7, v0
    v_mul_u32_u24 v4, 1088, v24
    v_xor_b32_e64 v24, 4, v24
    v_mul_u32_u24 v24, 1088, v24
    v_add_u32 v24, v24, v3
    v_add_u32 v3, v4, v3
    s_add_u32 s30, s30, s11
    s_lshl_b32 s30, s30, 5
    v_add_u32_e64 v8, s30, v5
    v_mul_u32_u24 v8, 896, v8
    v_and_b32_e64 v5, 7, v0
    v_lshl_add_u32 v8, v5, 4, v8
    s_lshl_b32 s29, s10, 7
    v_add_u32 v8, s29, v8
    s_waitcnt vmcnt(7)
    v_xor_b32 v67, v67, v9
    s_waitcnt vmcnt(6)
    v_xor_b32 v71, v71, v9
    s_waitcnt vmcnt(5)
    v_xor_b32 v75, v75, v9
    s_waitcnt vmcnt(4)
    v_xor_b32 v79, v79, v9
    v_or3_b32 v7, v67, v71, v75
    v_or_b32_e64 v7, v7, v79
    v_cmp_lt_u32 vcc, 0xffff, v7
    s_cbranch_vccnz L_slow_74
L_back_75:
    s_xor_b32 s29, s48, s2
    s_xor_b32 s30, s49, s2
    s_or_b32 s29, s29, s30
    s_cbranch_scc1 L_grc_78
L_grx_77:
    s_add_u32 s31, s58, 8192
    buffer_load_dwordx4 v[96:99], v6, s[32:35], s31 offen offset:0 sc1
    buffer_load_dwordx4 v[100:103], v6, s[32:35], s31 offen offset:1024 sc1
    buffer_load_dwordx4 v[104:107], v6, s[32:35], s31 offen offset:2048 sc1
    buffer_load_dwordx4 v[108:111], v6, s[32:35], s31 offen offset:3072 sc1
    v_mfma_f32_32x32x16_bf16 v[32:47], v[128:131], v[64:67], 0
    v_mfma_f32_32x32x16_bf16 v[48:63], v[192:195], v[64:67], 0
    v_mfma_f32_32x32x16_bf16 v[32:47], v[132:135], v[68:71], v[32:47]
    v_mfma_f32_32x32x16_bf16 v[48:63], v[196:199], v[68:71], v[48:63]
    v_mfma_f32_32x32x16_bf16 v[32:47], v[136:139], v[72:75], v[32:47]
    v_mfma_f32_32x32x16_bf16 v[48:63], v[200:203], v[72:75], v[48:63]
    v_mfma_f32_32x32x16_bf16 v[32:47], v[140:143], v[76:79], v[32:47]
    v_mfma_f32_32x32x16_bf16 v[48:63], v[204:207], v[76:79], v[48:63]
    s_waitcnt vmcnt(7)
    v_xor_b32 v83, v83, v9
    s_waitcnt vmcnt(6)
    v_xor_b32 v87, v87, v9
    s_waitcnt vmcnt(5)
    v_xor_b32 v91, v91, v9
    s_waitcnt vmcnt(4)
    v_xor_b32_e64 v95, v95, v9
    v_or3_b32 v7, v83, v87, v91
    v_or_b32_e64 v7, v7, v95
    v_cmp_lt_u32 vcc, 0xffff, v7
    s_cbranch_vccnz L_slow_79
L_back_80:
    s_xor_b32 s29, s50, s2
    s_xor_b32 s30, s51, s2
    s_or_b32 s29, s29, s30
    s_cbranch_scc1 L_grc_83
L_grx_82:
    s_add_u32 s31, s58, 12288
    buffer_load_dwordx4 v[112:115], v6, s[32:35], s31 offen offset:0 sc1
    buffer_load_dwordx4 v[116:119], v6, s[32:35], s31 offen offset:1024 sc1
    buffer_load_dwordx4 v[120:123], v6, s[32:35], s31 offen offset:2048 sc1
    buffer_load_dwordx4 v[124:127], v6, s[32:35], s31 offen offset:3072 sc1
    v_mfma_f32_32x32x16_bf16 v[32:47], v[144:147], v[80:83], v[32:47]
    v_mfma_f32_32x32x16_bf16 v[48:63], v[208:211], v[80:83], v[48:63]
    v_mfma_f32_32x32x16_bf16 v[32:47], v[148:151], v[84:87], v[32:47]
    v_mfma_f32_32x32x16_bf16 v[48:63], v[212:215], v[84:87], v[48:63]
    v_mfma_f32_32x32x16_bf16 v[32:47], v[152:155], v[88:91], v[32:47]
    v_mfma_f32_32x32x16_bf16 v[48:63], v[216:219], v[88:91], v[48:63]
    v_mfma_f32_32x32x16_bf16 v[32:47], v[156:159], v[92:95], v[32:47]
    v_mfma_f32_32x32x16_bf16 v[48:63], v[220:223], v[92:95], v[48:63]
    s_waitcnt vmcnt(7)
    v_xor_b32 v99, v99, v9
    s_waitcnt vmcnt(6)
    v_xor_b32 v103, v103, v9
    s_waitcnt vmcnt(5)
    v_xor_b32 v107, v107, v9
    s_waitcnt vmcnt(4)
    v_xor_b32_e64 v111, v111, v9
    v_or3_b32 v7, v99, v103, v107
    v_or_b32_e64 v7, v7, v111
    v_cmp_lt_u32 vcc, 0xffff, v7
    s_cbranch_vccnz L_slow_84
L_back_85:
    ds_read_b128 v[28:31], v10 offset:112
    ds_read_b128 v[20:23], v10 offset:160
    v_mfma_f32_32x32x16_bf16 v[32:47], v[160:163], v[96:99], v[32:47]
    v_mfma_f32_32x32x16_bf16 v[48:63], v[224:227], v[96:99], v[48:63]
    v_mfma_f32_32x32x16_bf16 v[32:47], v[164:167], v[100:103], v[32:47]
    v_mfma_f32_32x32x16_bf16 v[48:63], v[228:231], v[100:103], v[48:63]
    v_mfma_f32_32x32x16_bf16 v[32:47], v[168:171], v[104:107], v[32:47]
    v_mfma_f32_32x32x16_bf16 v[48:63], v[232:235], v[104:107], v[48:63]
    s_waitcnt lgkmcnt(1)
    v_min3_u32 v28, v28, v29, v30
    v_min_u32 v28, v28, v31
    v_cmp_gt_u32 vcc, 2, v28
    s_cbranch_vccnz L_slow_70
L_back_71:
    s_waitcnt lgkmcnt(0)
    v_min3_u32 v20, v20, v21, v22
    v_min_u32_e64 v20, v20, v23
    v_cmp_gt_u32 vcc, 2, v20
    s_cbranch_vccnz L_slow_72
L_back_73:
    v_mfma_f32_32x32x16_bf16 v[32:47], v[172:175], v[108:111], v[32:47]
    v_mfma_f32_32x32x16_bf16 v[48:63], v[236:239], v[108:111], v[48:63]
    s_waitcnt vmcnt(3)
    v_xor_b32 v115, v115, v9
    s_waitcnt vmcnt(2)
    v_xor_b32 v119, v119, v9
    s_waitcnt vmcnt(1)
    v_xor_b32 v123, v123, v9
    s_waitcnt vmcnt(0)
    v_xor_b32 v127, v127, v9
    v_or3_b32 v7, v115, v119, v123
    v_or_b32_e64 v7, v7, v127
    v_cmp_lt_u32 vcc, 0xffff, v7
    s_cbranch_vccnz L_slow_86
L_back_87:
    v_mfma_f32_32x32x16_bf16 v[48:63], v[240:243], v[112:115], v[48:63]
    v_mfma_f32_32x32x16_bf16 v[48:63], v[244:247], v[116:119], v[48:63]
    v_mfma_f32_32x32x16_bf16 v[48:63], v[248:251], v[120:123], v[48:63]
    v_mfma_f32_32x32x16_bf16 v[48:63], v[252:255], v[124:127], v[48:63]
    v_mfma_f32_32x32x16_bf16 v[32:47], v[176:179], v[112:115], v[32:47]
    v_mfma_f32_32x32x16_bf16 v[32:47], v[180:183], v[116:119], v[32:47]
    v_mfma_f32_32x32x16_bf16 v[32:47], v[184:187], v[120:123], v[32:47]
    v_mfma_f32_32x32x16_bf16 v[32:47], v[188:191], v[124:127], v[32:47]
    s_nop 7
    ds_write_b128 v2, v[48:51] offset:4352
    ds_write_b128 v2, v[52:55] offset:5440
    ds_write_b128 v2, v[56:59] offset:6528
    ds_write_b128 v2, v[60:63] offset:7616
    ds_write_b128 v2, v[32:35] offset:0
    ds_write_b128 v2, v[36:39] offset:1088
    ds_write_b128 v2, v[40:43] offset:2176
    ds_write_b128 v2, v[44:47] offset:3264
    s_waitcnt lgkmcnt(0)
    s_barrier
    ds_read_b128 v[64:67], v3 offset:0
    ds_read_b128 v[68:71], v3 offset:512
    ds_read_b128 v[72:75], v24 offset:17408
    ds_read_b128 v[76:79], v24 offset:17920
    ds_read_b128 v[80:83], v3 offset:34816
    ds_read_b128 v[84:87], v3 offset:35328
    ds_read_b128 v[88:91], v24 offset:52224
    ds_read_b128 v[92:95], v24 offset:52736
    s_waitcnt lgkmcnt(5)
    v_add_f32 v64, v64, v72
    v_add_f32 v65, v65, v73
    v_add_f32 v66, v66, v74
    v_add_f32 v67, v67, v75
    s_waitcnt lgkmcnt(4)
    v_add_f32 v68, v68, v76
    v_add_f32 v69, v69, v77
    v_add_f32 v70, v70, v78
    v_add_f32 v71, v71, v79
    s_waitcnt lgkmcnt(1)
    v_add_f32 v80, v80, v88
    v_add_f32 v81, v81, v89
    v_add_f32 v82, v82, v90
    v_add_f32 v83, v83, v91
    s_waitcnt lgkmcnt(0)
    v_add_f32 v84, v84, v92
    v_add_f32 v85, v85, v93
    v_add_f32 v86, v86, v94
    v_add_f32 v87, v87, v95
    v_add_f32 v64, v64, v80
    v_add_f32 v65, v65, v81
    v_cvt_pk_bf16_f32 v16, v64, v65
    v_add_f32 v66, v66, v82
    v_add_f32 v67, v67, v83
    v_cvt_pk_bf16_f32 v17, v66, v67
    v_add_f32 v68, v68, v84
    v_add_f32 v69, v69, v85
    v_cvt_pk_bf16_f32 v18, v68, v69
    v_add_f32 v70, v70, v86
    v_add_f32 v71, v71, v87
    v_cvt_pk_bf16_f32 v19, v70, v71
    buffer_store_dwordx4 v[16:19], v8, s[40:43], 0 offen sc1
    s_endpgm
L_sub_phi:
    s_setprio 0
    s_waitcnt lgkmcnt(0)
    s_mov_b32 s3, 0
L_sp_88:
    ds_read_b32 v28, v9 offset:96
    s_add_u32 s3, s3, 1
    s_cmp_gt_u32 s3, 60000
    s_cbranch_scc1 L_abort
    s_waitcnt lgkmcnt(0)
    v_cmp_le_u32 vcc, 1, v28
    s_cbranch_vccnz L_spx_89
    s_sleep 1
    s_branch L_sp_88
L_spx_89:
    s_setprio 3
    s_lshl_b32 s29, s101, 12
    v_add_u32 v24, s29, v1
    ds_read_b128 v[96:99], v24
    ds_read_b128 v[100:103], v24 offset:1024
    s_lshl_b32 s29, s101, 8
    s_add_u32 s29, s29, 160256
    v_lshl_add_u32 v26, v0, 2, s29
    s_waitcnt lgkmcnt(0)
    v_lshlrev_b32 v24, 16, v102
    v_lshlrev_b32 v25, 16, v102
    s_nop 1
    v_permlane32_swap_b32 v24, v25
    v_mul_f32_e64 v25, s67, v25
    v_exp_f32_e64 v25, -v25
    s_nop 0
    v_add_f32 v25, 1.0, v25
    v_rcp_f32 v25, v25
    s_nop 0
    ds_write_b32 v26, v25
    ds_add_u32 v13, v11 offset:176
    v_sub_f32 v27, 1.0, v25
    v_lshlrev_b32 v64, 16, v96
    v_and_b32 v65, 0xffff0000, v96
    v_mul_f32 v24, s67, v64
    v_mul_f32 v25, s67, v65
    v_exp_f32_e64 v24, v24 clamp
    v_exp_f32_e64 v25, v25 clamp
    v_max_f32 v64, 0, v64
    v_max_f32 v65, 0, v65
    v_add_f32 v64, v64, v24
    v_add_f32 v65, v65, v25
    v_add_f32 v64, s66, v64
    v_add_f32 v65, s66, v65
    v_cvt_pk_bf16_f32 v16, v64, v65
    v_lshlrev_b32_e64 v66, 16, v97
    v_and_b32 v67, 0xffff0000, v97
    v_mul_f32 v24, s67, v66
    v_mul_f32 v25, s67, v67
    v_exp_f32_e64 v24, v24 clamp
    v_exp_f32_e64 v25, v25 clamp
    v_max_f32 v66, 0, v66
    v_max_f32 v67, 0, v67
    v_add_f32 v66, v66, v24
    v_add_f32 v67, v67, v25
    v_add_f32 v66, s66, v66
    v_add_f32 v67, s66, v67
    v_cvt_pk_bf16_f32 v17, v66, v67
    v_lshlrev_b32_e64 v68, 16, v98
    v_and_b32 v69, 0xffff0000, v98
    v_mul_f32 v24, s67, v68
    v_mul_f32 v25, s67, v69
    v_exp_f32_e64 v24, v24 clamp
    v_exp_f32_e64 v25, v25 clamp
    v_max_f32 v68, 0, v68
    v_max_f32 v69, 0, v69
    v_add_f32 v68, v68, v24
    v_add_f32 v69, v69, v25
    v_add_f32 v68, s66, v68
    v_add_f32 v69, s66, v69
    v_cvt_pk_bf16_f32 v18, v68, v69
    v_lshlrev_b32_e64 v70, 16, v99
    v_and_b32 v71, 0xffff0000, v99
    v_mul_f32 v24, s67, v70
    v_mul_f32 v25, s67, v71
    v_exp_f32_e64 v24, v24 clamp
    v_exp_f32_e64 v25, v25 clamp
    v_max_f32 v70, 0, v70
    v_max_f32 v71, 0, v71
    v_add_f32 v70, v70, v24
    v_add_f32 v71, v71, v25
    v_add_f32 v70, s66, v70
    v_add_f32 v71, s66, v71
    v_cvt_pk_bf16_f32 v19, v70, v71
    s_cmp_eq_u32 s52, 0
    s_cbranch_scc1 L_sub_phib
    s_setpc_b64 s[54:55]
L_sub_phib:
    v_lshlrev_b32 v72, 16, v100
    v_and_b32 v73, 0xffff0000, v100
    v_mul_f32 v24, s67, v72
    v_mul_f32 v25, s67, v73
    v_exp_f32_e64 v24, v24 clamp
    v_exp_f32_e64 v25, v25 clamp
    v_max_f32 v72, 0, v72
    v_max_f32 v73, 0, v73
    v_add_f32 v72, v72, v24
    v_add_f32 v73, v73, v25
    v_add_f32 v72, s66, v72
    v_add_f32 v73, s66, v73
    v_cvt_pk_bf16_f32 v20, v72, v73
    v_lshlrev_b32_e64 v74, 16, v101
    v_and_b32 v75, 0xffff0000, v101
    v_mul_f32 v24, s67, v74
    v_mul_f32 v25, s67, v75
    v_exp_f32_e64 v24, v24 clamp
    v_exp_f32_e64 v25, v25 clamp
    v_max_f32 v74, 0, v74
    v_max_f32 v75, 0, v75
    v_add_f32 v74, v74, v24
    v_add_f32 v75, v75, v25
    v_add_f32 v74, s66, v74
    v_add_f32 v75, s66, v75
    v_cvt_pk_bf16_f32 v21, v74, v75
    v_lshlrev_b32_e64 v76, 16, v102
    v_and_b32 v77, 0xffff0000, v102
    v_mul_f32 v24, s67, v76
    v_mul_f32 v25, s67, v77
    v_exp_f32_e64 v24, v24 clamp
    v_exp_f32_e64 v25, v25 clamp
    v_max_f32 v76, 0, v76
    v_max_f32 v77, 0, v77
    v_add_f32 v76, v76, v24
    v_add_f32 v77, v77, v25
    v_add_f32 v76, s66, v76
    v_add_f32 v77, s66, v77
    v_cvt_pk_bf16_f32 v22, v76, v77
    v_lshlrev_b32_e64 v78, 16, v103
    v_and_b32 v79, 0xffff0000, v103
    v_mul_f32 v24, s67, v78
    v_mul_f32 v25, s67, v79
    v_exp_f32_e64 v24, v24 clamp
    v_exp_f32_e64 v25, v25 clamp
    v_max_f32 v78, 0, v78
    v_max_f32 v79, 0, v79
    v_add_f32 v78, v78, v24
    v_add_f32 v79, v79, v25
    v_add_f32 v78, s66, v78
    v_add_f32 v79, s66, v79
    v_cvt_pk_bf16_f32 v23, v78, v79
    v_and_b32 v22, v22, v14
    v_and_b32_e64 v23, v23, v14
    s_waitcnt lgkmcnt(0)
    s_setpc_b64 s[54:55]
L_sub_ob:
    s_setprio 0
    s_waitcnt lgkmcnt(0)
    s_mov_b32 s3, 0
L_sp_90:
    ds_read_b32 v28, v10 offset:204
    s_add_u32 s3, s3, 1
    s_cmp_gt_u32 s3, 60000
    s_cbranch_scc1 L_abort
    s_waitcnt lgkmcnt(0)
    v_cmp_le_u32 vcc, 1, v28
    s_cbranch_vccnz L_spx_91
    s_sleep 1
    s_branch L_sp_90
L_spx_91:
    s_setprio 3
    v_add_u32 v24, 161280, v1
    ds_read_b128 v[88:91], v24
    ds_read_b128 v[92:95], v24 offset:1024
    s_waitcnt lgkmcnt(1)
    v_mfma_f32_32x32x16_bf16 v[64:79], v[88:91], v[16:19], 0
    s_waitcnt lgkmcnt(0)
    v_mfma_f32_32x32x16_bf16 v[64:79], v[92:95], v[20:23], v[64:79]
    s_nop 11
    v_mov_b32 v24, v79
    v_mov_b32 v25, v79
    s_nop 1
    v_permlane32_swap_b32 v24, v25
    v_add_f32 v25, s66, v25
    v_rcp_f32_e64 v25, v25
    v_mov_b32 v24, 0xffff
    v_mul_f32 v25, v25, v27
    v_mul_f32 v64, v64, v25
    v_mul_f32_e64 v65, v65, v25
    v_cvt_pk_bf16_f32 v80, v64, v65
    v_mul_f32 v66, v66, v25
    v_mul_f32 v67, v67, v25
    v_cvt_pk_bf16_f32 v81, v66, v67
    v_mul_f32 v68, v68, v25
    v_mul_f32 v69, v69, v25
    v_cvt_pk_bf16_f32 v82, v68, v69
    v_mul_f32_e64 v70, v70, v25
    v_cvt_pk_bf16_f32 v83, v70, v71
    v_bfi_b32 v83, v24, v83, v15
    buffer_store_dwordx4 v[80:83], v1, s[32:35], s68 offen offset:0 sc1
    v_mul_f32 v72, v72, v25
    v_mul_f32 v73, v73, v25
    v_cvt_pk_bf16_f32 v84, v72, v73
    v_mul_f32 v74, v74, v25
    v_mul_f32 v75, v75, v25
    v_cvt_pk_bf16_f32 v85, v74, v75
    v_mul_f32 v76, v76, v25
    v_mul_f32 v77, v77, v25
    v_cvt_pk_bf16_f32 v86, v76, v77
    v_mul_f32_e64 v78, v78, v25
    v_cvt_pk_bf16_f32 v87, v78, v79
    v_bfi_b32 v87, v24, v87, v15
    buffer_store_dwordx4 v[84:87], v1, s[32:35], s68 offen offset:1024 sc1
    v_lshlrev_b32 v24, 7, v0
    s_mov_b64 exec, 1
    buffer_store_dword v15, v24, s[32:35], s62 offen sc1
    s_mov_b64 exec, -1
    s_waitcnt lgkmcnt(0)
    s_setpc_b64 s[54:55]
L_sub_r0:
    ds_read_b64_tr_b16 v[128:129], v248 offset:0
    ds_read_b64_tr_b16 v[130:131], v249 offset:0
    ds_read_b64_tr_b16 v[132:133], v250 offset:0
    ds_read_b64_tr_b16 v[134:135], v251 offset:0
    ds_read_b64_tr_b16 v[136:137], v248 offset:3584
    ds_read_b64_tr_b16 v[138:139], v249 offset:3584
    ds_read_b64_tr_b16 v[140:141], v250 offset:3584
    ds_read_b64_tr_b16 v[142:143], v251 offset:3584
    ds_read_b64_tr_b16 v[144:145], v248 offset:7168
    ds_read_b64_tr_b16 v[146:147], v249 offset:7168
    ds_read_b64_tr_b16 v[148:149], v250 offset:7168
    ds_read_b64_tr_b16 v[150:151], v251 offset:7168
    ds_read_b64_tr_b16 v[152:153], v248 offset:10752
    ds_read_b64_tr_b16 v[154:155], v249 offset:10752
    ds_read_b64_tr_b16 v[156:157], v250 offset:10752
    ds_read_b64_tr_b16 v[158:159], v251 offset:10752
    ds_read_b64_tr_b16 v[160:161], v248 offset:14336
    ds_read_b64_tr_b16 v[162:163], v249 offset:14336
    ds_read_b64_tr_b16 v[164:165], v250 offset:14336
    ds_read_b64_tr_b16 v[166:167], v251 offset:14336
    ds_read_b64_tr_b16 v[168:169], v248 offset:17920
    ds_read_b64_tr_b16 v[170:171], v249 offset:17920
    ds_read_b64_tr_b16 v[172:173], v250 offset:17920
    ds_read_b64_tr_b16 v[174:175], v251 offset:17920
    v_xor_b32 v248, 64, v248
    v_xor_b32 v249, 64, v249
    v_xor_b32 v250, 64, v250
    v_xor_b32_e64 v251, 64, v251
    ds_read_b64_tr_b16 v[192:193], v248 offset:0
    ds_read_b64_tr_b16 v[194:195], v249 offset:0
    ds_read_b64_tr_b16 v[196:197], v250 offset:0
    ds_read_b64_tr_b16 v[198:199], v251 offset:0
    ds_read_b64_tr_b16 v[200:201], v248 offset:3584
    ds_read_b64_tr_b16 v[202:203], v249 offset:3584
    ds_read_b64_tr_b16 v[204:205], v250 offset:3584
    ds_read_b64_tr_b16 v[206:207], v251 offset:3584
    ds_read_b64_tr_b16 v[208:209], v248 offset:7168
    ds_read_b64_tr_b16 v[210:211], v249 offset:7168
    ds_read_b64_tr_b16 v[212:213], v250 offset:7168
    ds_read_b64_tr_b16 v[214:215], v251 offset:7168
    ds_read_b64_tr_b16 v[216:217], v248 offset:10752
    ds_read_b64_tr_b16 v[218:219], v249 offset:10752
    ds_read_b64_tr_b16 v[220:221], v250 offset:10752
    ds_read_b64_tr_b16 v[222:223], v251 offset:10752
    ds_read_b64_tr_b16 v[224:225], v248 offset:14336
    ds_read_b64_tr_b16 v[226:227], v249 offset:14336
    ds_read_b64_tr_b16 v[228:229], v250 offset:14336
    ds_read_b64_tr_b16 v[230:231], v251 offset:14336
    ds_read_b64_tr_b16 v[232:233], v248 offset:17920
    ds_read_b64_tr_b16 v[234:235], v249 offset:17920
    ds_read_b64_tr_b16 v[236:237], v250 offset:17920
    ds_read_b64_tr_b16 v[238:239], v251 offset:17920
    v_xor_b32 v248, 64, v248
    v_xor_b32 v249, 64, v249
    v_xor_b32 v250, 64, v250
    v_xor_b32 v251, 64, v251
    ds_add_u32 v13, v11 offset:160
    s_waitcnt lgkmcnt(0)
    s_setpc_b64 s[54:55]
L_sub_r1:
    ds_read_b64_tr_b16 v[176:177], v2 offset:0
    ds_read_b64_tr_b16 v[178:179], v3 offset:0
    ds_read_b64_tr_b16 v[180:181], v4 offset:0
    ds_read_b64_tr_b16 v[182:183], v5 offset:0
    ds_read_b64_tr_b16 v[184:185], v2 offset:3584
    ds_read_b64_tr_b16 v[186:187], v3 offset:3584
    ds_read_b64_tr_b16 v[188:189], v4 offset:3584
    ds_read_b64_tr_b16 v[190:191], v5 offset:3584
    v_xor_b32 v2, 64, v2
    v_xor_b32 v3, 64, v3
    v_xor_b32 v4, 64, v4
    v_xor_b32 v5, 64, v5
    ds_read_b64_tr_b16 v[240:241], v2 offset:0
    ds_read_b64_tr_b16 v[242:243], v3 offset:0
    ds_read_b64_tr_b16 v[244:245], v4 offset:0
    ds_read_b64_tr_b16 v[246:247], v5 offset:0
    ds_read_b64_tr_b16 v[248:249], v2 offset:3584
    ds_read_b64_tr_b16 v[250:251], v3 offset:3584
    ds_read_b64_tr_b16 v[252:253], v4 offset:3584
    ds_read_b64_tr_b16 v[254:255], v5 offset:3584
    v_xor_b32 v2, 64, v2
    v_xor_b32 v3, 64, v3
    v_xor_b32 v4, 64, v4
    v_xor_b32 v5, 64, v5
    ds_add_u32 v13, v11 offset:160
    s_waitcnt lgkmcnt(0)
    s_setpc_b64 s[54:55]
L_sub_d7:
    s_waitcnt vmcnt(19)
    buffer_load_dwordx4 v8, s[36:39], s72 offen lds
    s_add_u32 s72, s72, s53
    s_addk_i32 m0, 1024
    s_waitcnt vmcnt(19)
    buffer_load_dwordx4 v8, s[36:39], s72 offen lds
    s_add_u32 s72, s72, s53
    s_addk_i32 m0, 1024
    s_waitcnt vmcnt(19)
    buffer_load_dwordx4 v8, s[36:39], s72 offen lds
    s_add_u32 s72, s72, s53
    s_addk_i32 m0, 1024
    s_waitcnt vmcnt(19)
    buffer_load_dwordx4 v8, s[36:39], s72 offen lds
    s_add_u32 s72, s72, s53
    s_addk_i32 m0, 1024
    s_waitcnt vmcnt(19)
    buffer_load_dwordx4 v8, s[36:39], s72 offen lds
    s_add_u32 s72, s72, s53
    s_addk_i32 m0, 1024
    s_waitcnt vmcnt(19)
    buffer_load_dwordx4 v8, s[36:39], s72 offen lds
    s_add_u32 s72, s72, s53
    s_addk_i32 m0, 1024
    s_waitcnt vmcnt(19)
    buffer_load_dwordx4 v8, s[36:39], s72 offen lds
    s_add_u32 s72, s72, s53
    s_addk_i32 m0, 1024
    s_setpc_b64 s[54:55]
L_sub_d7e:
    s_waitcnt vmcnt(13)
    buffer_load_dwordx4 v8, s[36:39], s72 offen lds
    s_add_u32 s72, s72, s53
    s_addk_i32 m0, 1024
    s_waitcnt vmcnt(13)
    buffer_load_dwordx4 v8, s[36:39], s72 offen lds
    s_add_u32 s72, s72, s53
    s_addk_i32 m0, 1024
    s_waitcnt vmcnt(13)
    buffer_load_dwordx4 v8, s[36:39], s72 offen lds
    s_add_u32 s72, s72, s53
    s_addk_i32 m0, 1024
    s_waitcnt vmcnt(13)
    buffer_load_dwordx4 v8, s[36:39], s72 offen lds
    s_add_u32 s72, s72, s53
    s_addk_i32 m0, 1024
    s_waitcnt vmcnt(13)
    buffer_load_dwordx4 v8, s[36:39], s72 offen lds
    s_add_u32 s72, s72, s53
    s_addk_i32 m0, 1024
    s_waitcnt vmcnt(13)
    buffer_load_dwordx4 v8, s[36:39], s72 offen lds
    s_add_u32 s72, s72, s53
    s_addk_i32 m0, 1024
    s_waitcnt vmcnt(13)
    buffer_load_dwordx4 v8, s[36:39], s72 offen lds
    s_add_u32 s72, s72, s53
    s_addk_i32 m0, 1024
    s_setpc_b64 s[54:55]
L_cwave:
    v_lshlrev_b32 v20, 3, v0
    v_mov_b32 v22, 0
    v_mov_b32_e64 v23, 0
    v_add_u32 v20, 158720, v20
    ds_write_b64 v20, v[22:23]
    v_and_b32 v20, 31, v0
    v_lshrrev_b32 v21, 5, v0
    s_lshl_b32 s75, s26, 2
    s_add_u32 s75, s75, s24
    s_mov_b32 s72, 0x3fb8aa3b
    s_mov_b32 s73, 0x358637bd
    s_mov_b32 s39, 0x3e8b97f6
    v_bfe_u32 v22, v0, 1, 3
    v_xor_b32 v22, v22, v21
    s_lshl_b32 s29, s24, 12
    v_add_u32 v15, s29, v1
    v_lshlrev_b32 v23, 7, v20
    v_add_u32 v23, s29, v23
    v_xor_b32 v24, 0, v22
    v_lshl_add_u32 v2, v24, 4, v23
    v_xor_b32_e64 v24, 2, v22
    v_lshl_add_u32 v3, v24, 4, v23
    v_xor_b32_e64 v24, 4, v22
    v_lshl_add_u32 v4, v24, 4, v23
    v_xor_b32_e64 v24, 6, v22
    v_lshl_add_u32 v5, v24, 4, v23
    v_bfe_u32 v25, v0, 2, 2
    v_bfe_u32 v22, v0, 4, 1
    v_and_b32_e64 v26, 3, v0
    v_lshl_add_u32 v26, v22, 2, v26
    v_lshl_add_u32 v27, v21, 3, v25
    v_lshrrev_b32 v22, 1, v25
    v_lshlrev_b32 v23, 7, v27
    v_add_u32 v23, 65536, v23
    v_lshl_add_u32 v6, v22, 6, v23
    v_xor_b32_e64 v7, 64, v6
    v_lshl_add_u32 v6, v26, 3, v6
    s_xor_b32 s29, s74, 1
    v_add_u32 v24, s29, v26
    v_and_b32_e64 v24, 7, v24
    v_lshl_add_u32 v7, v24, 3, v7
    v_lshlrev_b32 v23, 6, v27
    v_add_u32 v24, s27, v26
    v_and_b32_e64 v24, 7, v24
    v_lshl_add_u32 v8, v24, 3, v23
    v_add_u32 v8, 114688, v8
    v_and_b32 v22, 1, v26
    v_lshlrev_b32 v22, 1, v22
    v_bfe_u32 v24, v26, 1, 1
    v_or_b32 v22, v22, v24
    v_and_b32 v24, 4, v26
    v_or_b32_e64 v22, v22, v24
    v_lshl_add_u32 v9, v22, 3, v23
    v_add_u32 v9, 114688, v9
    v_add_u32 v14, -1, v21
    s_sub_u32 s29, s27, 1
    v_not_b32 v22, v14
    v_or_b32 v248, s29, v22
    s_not_b32 s29, s29
    v_or_b32 v249, s29, v14
    v_lshlrev_b32 v22, 2, v21
    v_sub_u32 v22, v20, v22
    v_cmp_le_i32 s[40:41], 0, v22
    v_cmp_le_i32 s[42:43], 1, v22
    v_cmp_le_i32 s[44:45], 2, v22
    v_cmp_le_i32 s[46:47], 3, v22
    v_cmp_le_i32 s[48:49], 8, v22
    v_cmp_le_i32 s[50:51], 9, v22
    v_cmp_le_i32 s[52:53], 10, v22
    v_cmp_le_i32 s[54:55], 11, v22
    v_cmp_le_i32 s[56:57], 16, v22
    v_cmp_le_i32 s[58:59], 17, v22
    v_cmp_le_i32 s[60:61], 18, v22
    v_cmp_le_i32 s[62:63], 19, v22
    v_cmp_le_i32 s[64:65], 24, v22
    v_cmp_le_i32 s[66:67], 25, v22
    v_cmp_le_i32 s[68:69], 26, v22
    v_cmp_le_i32 s[70:71], 27, v22
    v_mov_b32 v23, 0xffff
    v_mov_b32 v24, 0xffff0000
    v_cndmask_b32 v56, 0, v23, s[40:41]
    v_cndmask_b32 v22, 0, v24, s[42:43]
    v_or_b32_e64 v56, v56, v22
    v_cndmask_b32 v57, 0, v23, s[44:45]
    v_cndmask_b32 v22, 0, v24, s[46:47]
    v_or_b32_e64 v57, v57, v22
    v_cndmask_b32 v58, 0, v23, s[48:49]
    v_cndmask_b32 v22, 0, v24, s[50:51]
    v_or_b32_e64 v58, v58, v22
    v_cndmask_b32 v59, 0, v23, s[52:53]
    v_cndmask_b32 v22, 0, v24, s[54:55]
    v_or_b32_e64 v59, v59, v22
    v_cndmask_b32 v60, 0, v23, s[56:57]
    v_cndmask_b32 v22, 0, v24, s[58:59]
    v_or_b32_e64 v60, v60, v22
    v_cndmask_b32 v61, 0, v23, s[60:61]
    v_cndmask_b32 v22, 0, v24, s[62:63]
    v_or_b32_e64 v61, v61, v22
    v_cndmask_b32 v62, 0, v23, s[64:65]
    v_cndmask_b32 v22, 0, v24, s[66:67]
    v_or_b32_e64 v62, v62, v22
    v_cndmask_b32 v63, 0, v23, s[68:69]
    v_cndmask_b32 v22, 0, v24, s[70:71]
    v_or_b32 v63, v63, v22
    s_waitcnt lgkmcnt(0)
    s_mov_b32 s1, s2
    s_barrier
    s_mov_b32 s32, s22
    s_mov_b32 s33, s23
    s_mov_b32 s34, 16777216
    s_mov_b32 s35, 0x20000
    s_cmp_eq_u32 s24, 1
    s_cselect_b32 s16, s6, s12
    s_cselect_b32 s17, s7, s13
    s_mov_b32 s10, 1204224
    s_mov_b32 s11, 0x20000
    s_cmp_eq_u32 s24, 0
    s_cselect_b32 s8, s4, s16
    s_cselect_b32 s9, s5, s17
    s_cselect_b32 s10, 1835008, s10
    s_cselect_b32 s29, 40, 18
    s_mul_i32 s30, s29, s2
    v_add_u32_e64 v16, s30, v0
    s_mov_b32 s16, 9363
    s_cselect_b32 s16, 52429, s16
    s_cselect_b32 s17, 18, 17
    v_mul_u32_u24 v17, s16, v16
    v_lshrrev_b32_e64 v17, s17, v17
    s_mov_b32 s16, 896
    s_cselect_b32 s16, 256, s16
    v_mul_u32_u24 v17, s16, v17
    s_mov_b32 s16, 344960
    s_cselect_b32 s16, 256, s16
    v_lshl_add_u32 v16, v16, 7, v17
    v_add_u32_e64 v16, s16, v16
    v_cmp_gt_u32 vcc, s29, v0
    s_cmp_lt_u32 s24, 3
    s_cselect_b64 exec, vcc, 1
    buffer_load_dword v238, v16, s[8:11], 0 offen
    s_mov_b64 exec, -1
    s_cmp_eq_u32 s74, 0
    s_cbranch_scc1 L_cY
    s_waitcnt lgkmcnt(0)
    s_mov_b32 s3, 0
L_wl_92:
    ds_read_b32 v252, v10 offset:256
    s_add_u32 s3, s3, 1
    s_cmp_gt_u32 s3, 60000
    s_cbranch_scc1 L_abort
    s_waitcnt lgkmcnt(0)
    v_cmp_ne_u32 vcc, 2, v252
    s_cbranch_vccnz L_wl_92
    ds_read_b128 v[128:131], v2 offset:0
    ds_read_b64_tr_b16 v[32:33], v6 offset:0
    ds_read_b64_tr_b16 v[34:35], v6 offset:512
    ds_read_b64_tr_b16 v[36:37], v7 offset:0
    ds_read_b64_tr_b16 v[38:39], v7 offset:512
    ds_read_b64_tr_b16 v[40:41], v6 offset:8192
    ds_read_b64_tr_b16 v[42:43], v6 offset:8704
    ds_read_b64_tr_b16 v[44:45], v7 offset:8192
    ds_read_b64_tr_b16 v[46:47], v7 offset:8704
    s_waitcnt lgkmcnt(4)
    v_mfma_f32_32x32x16_bf16 v[64:79], v[32:35], v[128:131], 0
    ds_read_b128 v[132:135], v3 offset:0
    ds_read_b64_tr_b16 v[48:49], v6 offset:2048
    ds_read_b64_tr_b16 v[50:51], v6 offset:2560
    ds_read_b64_tr_b16 v[52:53], v7 offset:2048
    ds_read_b64_tr_b16 v[54:55], v7 offset:2560
    ds_read_b64_tr_b16 v[32:33], v6 offset:10240
    ds_read_b64_tr_b16 v[34:35], v6 offset:10752
    v_mfma_f32_32x32x16_bf16 v[80:95], v[36:39], v[128:131], 0
    ds_read_b64_tr_b16 v[36:37], v7 offset:10240
    ds_read_b64_tr_b16 v[38:39], v7 offset:10752
    s_waitcnt lgkmcnt(9)
    v_mfma_f32_32x32x16_bf16 v[96:111], v[128:131], v[40:43], 0
    ds_read_b128 v[136:139], v4 offset:0
    ds_read_b64_tr_b16 v[40:41], v6 offset:4096
    ds_read_b64_tr_b16 v[42:43], v6 offset:4608
    v_mfma_f32_32x32x16_bf16 v[112:127], v[128:131], v[44:47], 0
    ds_read_b64_tr_b16 v[44:45], v7 offset:4096
    ds_read_b64_tr_b16 v[46:47], v7 offset:4608
    s_waitcnt lgkmcnt(9)
    v_mfma_f32_32x32x16_bf16 v[64:79], v[48:51], v[132:135], v[64:79]
    ds_read_b64_tr_b16 v[48:49], v6 offset:12288
    ds_read_b64_tr_b16 v[50:51], v6 offset:12800
    v_mfma_f32_32x32x16_bf16 v[80:95], v[52:55], v[132:135], v[80:95]
    ds_read_b64_tr_b16 v[52:53], v7 offset:12288
    ds_read_b64_tr_b16 v[54:55], v7 offset:12800
    s_waitcnt lgkmcnt(9)
    v_mfma_f32_32x32x16_bf16 v[96:111], v[132:135], v[32:35], v[96:111]
    ds_read_b128 v[140:143], v5 offset:0
    ds_read_b64_tr_b16 v[32:33], v6 offset:6144
    ds_read_b64_tr_b16 v[34:35], v6 offset:6656
    v_mfma_f32_32x32x16_bf16 v[112:127], v[132:135], v[36:39], v[112:127]
    ds_read_b64_tr_b16 v[36:37], v7 offset:6144
    ds_read_b64_tr_b16 v[38:39], v7 offset:6656
    s_waitcnt lgkmcnt(9)
    v_mfma_f32_32x32x16_bf16 v[64:79], v[40:43], v[136:139], v[64:79]
    ds_read_b64_tr_b16 v[40:41], v6 offset:14336
    ds_read_b64_tr_b16 v[42:43], v6 offset:14848
    ds_read_b32 v254, v10 offset:260
    v_mfma_f32_32x32x16_bf16 v[80:95], v[44:47], v[136:139], v[80:95]
    ds_read_b64_tr_b16 v[44:45], v7 offset:14336
    ds_read_b64_tr_b16 v[46:47], v7 offset:14848
    ds_add_u32 v13, v11 offset:0
    s_waitcnt lgkmcnt(11)
    v_mfma_f32_32x32x16_bf16 v[96:111], v[136:139], v[48:51], v[96:111]
    s_waitcnt lgkmcnt(3)
    v_cmp_eq_u32 vcc, 2, v254
    s_cbranch_vccnz L_back_95
    s_mov_b32 s3, 0
L_slow_94:
    ds_read_b32 v254, v10 offset:260
    s_add_u32 s3, s3, 1
    s_cmp_gt_u32 s3, 60000
    s_cbranch_scc1 L_abort
    s_waitcnt lgkmcnt(0)
    v_cmp_ne_u32 vcc, 2, v254
    s_cbranch_vccnz L_slow_94
L_back_95:
    ds_read_b128 v[144:147], v2 offset:16384
    ds_read_b64_tr_b16 v[48:49], v6 offset:16384
    ds_read_b64_tr_b16 v[50:51], v6 offset:16896
    v_mfma_f32_32x32x16_bf16 v[112:127], v[136:139], v[52:55], v[112:127]
    ds_read_b64_tr_b16 v[52:53], v7 offset:16384
    ds_read_b64_tr_b16 v[54:55], v7 offset:16896
    v_mfma_f32_32x32x16_bf16 v[64:79], v[32:35], v[140:143], v[64:79]
    ds_read_b64_tr_b16 v[32:33], v6 offset:24576
    ds_read_b64_tr_b16 v[34:35], v6 offset:25088
    v_mfma_f32_32x32x16_bf16 v[80:95], v[36:39], v[140:143], v[80:95]
    ds_read_b64_tr_b16 v[36:37], v7 offset:24576
    ds_read_b64_tr_b16 v[38:39], v7 offset:25088
    s_waitcnt lgkmcnt(10)
    v_mfma_f32_32x32x16_bf16 v[96:111], v[140:143], v[40:43], v[96:111]
    ds_read_b128 v[148:151], v3 offset:16384
    ds_read_b64_tr_b16 v[40:41], v6 offset:18432
    ds_read_b64_tr_b16 v[42:43], v6 offset:18944
    v_mfma_f32_32x32x16_bf16 v[112:127], v[140:143], v[44:47], v[112:127]
    ds_read_b64_tr_b16 v[44:45], v7 offset:18432
    ds_read_b64_tr_b16 v[46:47], v7 offset:18944
    s_waitcnt lgkmcnt(9)
    v_mfma_f32_32x32x16_bf16 v[64:79], v[48:51], v[144:147], v[64:79]
    ds_read_b64_tr_b16 v[48:49], v6 offset:26624
    ds_read_b64_tr_b16 v[50:51], v6 offset:27136
    v_mfma_f32_32x32x16_bf16 v[80:95], v[52:55], v[144:147], v[80:95]
    ds_read_b64_tr_b16 v[52:53], v7 offset:26624
    ds_read_b64_tr_b16 v[54:55], v7 offset:27136
    s_waitcnt lgkmcnt(9)
    v_mfma_f32_32x32x16_bf16 v[96:111], v[144:147], v[32:35], v[96:111]
    ds_read_b128 v[152:155], v4 offset:16384
    ds_read_b64_tr_b16 v[32:33], v6 offset:20480
    ds_read_b64_tr_b16 v[34:35], v6 offset:20992
    v_mfma_f32_32x32x16_bf16 v[112:127], v[144:147], v[36:39], v[112:127]
    ds_read_b64_tr_b16 v[36:37], v7 offset:20480
    ds_read_b64_tr_b16 v[38:39], v7 offset:20992
    s_waitcnt lgkmcnt(9)
    v_mfma_f32_32x32x16_bf16 v[64:79], v[40:43], v[148:151], v[64:79]
    ds_read_b64_tr_b16 v[40:41], v6 offset:28672
    ds_read_b64_tr_b16 v[42:43], v6 offset:29184
    v_mfma_f32_32x32x16_bf16 v[80:95], v[44:47], v[148:151], v[80:95]
    ds_read_b64_tr_b16 v[44:45], v7 offset:28672
    ds_read_b64_tr_b16 v[46:47], v7 offset:29184
    s_waitcnt lgkmcnt(9)
    v_mfma_f32_32x32x16_bf16 v[96:111], v[148:151], v[48:51], v[96:111]
    ds_read_b128 v[156:159], v5 offset:16384
    ds_read_b64_tr_b16 v[48:49], v6 offset:22528
    ds_read_b64_tr_b16 v[50:51], v6 offset:23040
    v_mfma_f32_32x32x16_bf16 v[112:127], v[148:151], v[52:55], v[112:127]
    ds_read_b64_tr_b16 v[52:53], v7 offset:22528
    ds_read_b64_tr_b16 v[54:55], v7 offset:23040
    s_waitcnt lgkmcnt(9)
    v_mfma_f32_32x32x16_bf16 v[64:79], v[32:35], v[152:155], v[64:79]
    ds_read_b64_tr_b16 v[32:33], v6 offset:30720
    ds_read_b64_tr_b16 v[34:35], v6 offset:31232
    ds_read_b32 v254, v10 offset:264
    v_mfma_f32_32x32x16_bf16 v[80:95], v[36:39], v[152:155], v[80:95]
    ds_read_b64_tr_b16 v[36:37], v7 offset:30720
    ds_read_b64_tr_b16 v[38:39], v7 offset:31232
    ds_add_u32 v13, v11 offset:0
    s_waitcnt lgkmcnt(11)
    v_mfma_f32_32x32x16_bf16 v[96:111], v[152:155], v[40:43], v[96:111]
    s_waitcnt lgkmcnt(3)
    v_cmp_eq_u32 vcc, 2, v254
    s_cbranch_vccnz L_back_97
    s_mov_b32 s3, 0
L_slow_96:
    ds_read_b32 v254, v10 offset:264
    s_add_u32 s3, s3, 1
    s_cmp_gt_u32 s3, 60000
    s_cbranch_scc1 L_abort
    s_waitcnt lgkmcnt(0)
    v_cmp_ne_u32 vcc, 2, v254
    s_cbranch_vccnz L_slow_96
L_back_97:
    ds_read_b128 v[160:163], v2 offset:32768
    ds_read_b64_tr_b16 v[40:41], v6 offset:32768
    ds_read_b64_tr_b16 v[42:43], v6 offset:33280
    v_mfma_f32_32x32x16_bf16 v[112:127], v[152:155], v[44:47], v[112:127]
    ds_read_b64_tr_b16 v[44:45], v7 offset:32768
    ds_read_b64_tr_b16 v[46:47], v7 offset:33280
    v_mfma_f32_32x32x16_bf16 v[64:79], v[48:51], v[156:159], v[64:79]
    ds_read_b64_tr_b16 v[48:49], v6 offset:40960
    ds_read_b64_tr_b16 v[50:51], v6 offset:41472
    v_mfma_f32_32x32x16_bf16 v[80:95], v[52:55], v[156:159], v[80:95]
    ds_read_b64_tr_b16 v[52:53], v7 offset:40960
    ds_read_b64_tr_b16 v[54:55], v7 offset:41472
    s_waitcnt lgkmcnt(10)
    v_mfma_f32_32x32x16_bf16 v[96:111], v[156:159], v[32:35], v[96:111]
    ds_read_b128 v[164:167], v3 offset:32768
    ds_read_b64_tr_b16 v[32:33], v6 offset:34816
    ds_read_b64_tr_b16 v[34:35], v6 offset:35328
    v_mfma_f32_32x32x16_bf16 v[112:127], v[156:159], v[36:39], v[112:127]
    ds_read_b64_tr_b16 v[36:37], v7 offset:34816
    ds_read_b64_tr_b16 v[38:39], v7 offset:35328
    s_waitcnt lgkmcnt(9)
    v_mfma_f32_32x32x16_bf16 v[64:79], v[40:43], v[160:163], v[64:79]
    ds_read_b64_tr_b16 v[40:41], v6 offset:43008
    ds_read_b64_tr_b16 v[42:43], v6 offset:43520
    v_mfma_f32_32x32x16_bf16 v[80:95], v[44:47], v[160:163], v[80:95]
    ds_read_b64_tr_b16 v[44:45], v7 offset:43008
    ds_read_b64_tr_b16 v[46:47], v7 offset:43520
    s_waitcnt lgkmcnt(9)
    v_mfma_f32_32x32x16_bf16 v[96:111], v[160:163], v[48:51], v[96:111]
    ds_read_b128 v[168:171], v4 offset:32768
    ds_read_b64_tr_b16 v[48:49], v6 offset:36864
    ds_read_b64_tr_b16 v[50:51], v6 offset:37376
    v_mfma_f32_32x32x16_bf16 v[112:127], v[160:163], v[52:55], v[112:127]
    ds_read_b64_tr_b16 v[52:53], v7 offset:36864
    ds_read_b64_tr_b16 v[54:55], v7 offset:37376
    s_waitcnt lgkmcnt(9)
    v_mfma_f32_32x32x16_bf16 v[64:79], v[32:35], v[164:167], v[64:79]
    ds_read_b64_tr_b16 v[32:33], v6 offset:45056
    ds_read_b64_tr_b16 v[34:35], v6 offset:45568
    v_mfma_f32_32x32x16_bf16 v[80:95], v[36:39], v[164:167], v[80:95]
    ds_read_b64_tr_b16 v[36:37], v7 offset:45056
    ds_read_b64_tr_b16 v[38:39], v7 offset:45568
    s_waitcnt lgkmcnt(9)
    v_mfma_f32_32x32x16_bf16 v[96:111], v[164:167], v[40:43], v[96:111]
    ds_read_b128 v[172:175], v5 offset:32768
    ds_read_b64_tr_b16 v[40:41], v6 offset:38912
    ds_read_b64_tr_b16 v[42:43], v6 offset:39424
    v_mfma_f32_32x32x16_bf16 v[112:127], v[164:167], v[44:47], v[112:127]
    ds_read_b64_tr_b16 v[44:45], v7 offset:38912
    ds_read_b64_tr_b16 v[46:47], v7 offset:39424
    s_waitcnt lgkmcnt(9)
    v_mfma_f32_32x32x16_bf16 v[64:79], v[48:51], v[168:171], v[64:79]
    ds_read_b64_tr_b16 v[48:49], v6 offset:47104
    ds_read_b64_tr_b16 v[50:51], v6 offset:47616
    ds_read_b32 v254, v10 offset:268
    v_mfma_f32_32x32x16_bf16 v[80:95], v[52:55], v[168:171], v[80:95]
    ds_read_b64_tr_b16 v[52:53], v7 offset:47104
    ds_read_b64_tr_b16 v[54:55], v7 offset:47616
    ds_add_u32 v13, v11 offset:0
    s_waitcnt lgkmcnt(11)
    v_mfma_f32_32x32x16_bf16 v[96:111], v[168:171], v[32:35], v[96:111]
    s_waitcnt lgkmcnt(3)
    v_cmp_eq_u32 vcc, 2, v254
    s_cbranch_vccnz L_back_99
    s_mov_b32 s3, 0
L_slow_98:
    ds_read_b32 v254, v10 offset:268
    s_add_u32 s3, s3, 1
    s_cmp_gt_u32 s3, 60000
    s_cbranch_scc1 L_abort
    s_waitcnt lgkmcnt(0)
    v_cmp_ne_u32 vcc, 2, v254
    s_cbranch_vccnz L_slow_98
L_back_99:
    ds_read_b128 v[176:179], v2 offset:49152
    ds_read_b64_tr_b16 v[32:33], v6 offset:49152
    ds_read_b64_tr_b16 v[34:35], v6 offset:49664
    v_mfma_f32_32x32x16_bf16 v[112:127], v[168:171], v[36:39], v[112:127]
    ds_read_b64_tr_b16 v[36:37], v7 offset:49152
    ds_read_b64_tr_b16 v[38:39], v7 offset:49664
    v_mfma_f32_32x32x16_bf16 v[64:79], v[40:43], v[172:175], v[64:79]
    ds_read_b64_tr_b16 v[40:41], v6 offset:57344
    ds_read_b64_tr_b16 v[42:43], v6 offset:57856
    v_mfma_f32_32x32x16_bf16 v[80:95], v[44:47], v[172:175], v[80:95]
    ds_read_b64_tr_b16 v[44:45], v7 offset:57344
    ds_read_b64_tr_b16 v[46:47], v7 offset:57856
    s_waitcnt lgkmcnt(10)
    v_mfma_f32_32x32x16_bf16 v[96:111], v[172:175], v[48:51], v[96:111]
    ds_read_b128 v[180:183], v3 offset:49152
    ds_read_b64_tr_b16 v[48:49], v6 offset:51200
    ds_read_b64_tr_b16 v[50:51], v6 offset:51712
    v_mfma_f32_32x32x16_bf16 v[112:127], v[172:175], v[52:55], v[112:127]
    ds_read_b64_tr_b16 v[52:53], v7 offset:51200
    ds_read_b64_tr_b16 v[54:55], v7 offset:51712
    s_waitcnt lgkmcnt(9)
    v_mfma_f32_32x32x16_bf16 v[64:79], v[32:35], v[176:179], v[64:79]
    ds_read_b64_tr_b16 v[32:33], v6 offset:59392
    ds_read_b64_tr_b16 v[34:35], v6 offset:59904
    v_mfma_f32_32x32x16_bf16 v[80:95], v[36:39], v[176:179], v[80:95]
    ds_read_b64_tr_b16 v[36:37], v7 offset:59392
    ds_read_b64_tr_b16 v[38:39], v7 offset:59904
    s_waitcnt lgkmcnt(9)
    v_mfma_f32_32x32x16_bf16 v[96:111], v[176:179], v[40:43], v[96:111]
    ds_read_b128 v[184:187], v4 offset:49152
    ds_read_b64_tr_b16 v[40:41], v6 offset:53248
    ds_read_b64_tr_b16 v[42:43], v6 offset:53760
    v_mfma_f32_32x32x16_bf16 v[112:127], v[176:179], v[44:47], v[112:127]
    ds_read_b64_tr_b16 v[44:45], v7 offset:53248
    ds_read_b64_tr_b16 v[46:47], v7 offset:53760
    s_waitcnt lgkmcnt(9)
    v_mfma_f32_32x32x16_bf16 v[64:79], v[48:51], v[180:183], v[64:79]
    ds_read_b64_tr_b16 v[48:49], v6 offset:61440
    ds_read_b64_tr_b16 v[50:51], v6 offset:61952
    v_mfma_f32_32x32x16_bf16 v[80:95], v[52:55], v[180:183], v[80:95]
    ds_read_b64_tr_b16 v[52:53], v7 offset:61440
    ds_read_b64_tr_b16 v[54:55], v7 offset:61952
    s_waitcnt lgkmcnt(9)
    v_mfma_f32_32x32x16_bf16 v[96:111], v[180:183], v[32:35], v[96:111]
    ds_read_b128 v[188:191], v5 offset:49152
    ds_read_b64_tr_b16 v[32:33], v6 offset:55296
    ds_read_b64_tr_b16 v[34:35], v6 offset:55808
    v_mfma_f32_32x32x16_bf16 v[112:127], v[180:183], v[36:39], v[112:127]
    ds_read_b64_tr_b16 v[36:37], v7 offset:55296
    ds_read_b64_tr_b16 v[38:39], v7 offset:55808
    s_waitcnt lgkmcnt(9)
    v_mfma_f32_32x32x16_bf16 v[64:79], v[40:43], v[184:187], v[64:79]
    ds_read_b64_tr_b16 v[40:41], v6 offset:63488
    ds_read_b64_tr_b16 v[42:43], v6 offset:64000
    ds_read_b32 v254, v10 offset:272
    v_mfma_f32_32x32x16_bf16 v[80:95], v[44:47], v[184:187], v[80:95]
    ds_read_b64_tr_b16 v[44:45], v7 offset:63488
    ds_read_b64_tr_b16 v[46:47], v7 offset:64000
    ds_add_u32 v13, v11 offset:0
    s_waitcnt lgkmcnt(11)
    v_mfma_f32_32x32x16_bf16 v[96:111], v[184:187], v[48:51], v[96:111]
    s_waitcnt lgkmcnt(3)
    v_cmp_eq_u32 vcc, 2, v254
    s_cbranch_vccnz L_back_101
    s_mov_b32 s3, 0
L_slow_100:
    ds_read_b32 v254, v10 offset:272
    s_add_u32 s3, s3, 1
    s_cmp_gt_u32 s3, 60000
    s_cbranch_scc1 L_abort
    s_waitcnt lgkmcnt(0)
    v_cmp_ne_u32 vcc, 2, v254
    s_cbranch_vccnz L_slow_100
L_back_101:
    ds_read_b128 v[192:195], v2 offset:0
    ds_read_b64_tr_b16 v[48:49], v6 offset:0
    ds_read_b64_tr_b16 v[50:51], v6 offset:512
    v_mfma_f32_32x32x16_bf16 v[112:127], v[184:187], v[52:55], v[112:127]
    ds_read_b64_tr_b16 v[52:53], v7 offset:0
    ds_read_b64_tr_b16 v[54:55], v7 offset:512
    v_mfma_f32_32x32x16_bf16 v[64:79], v[32:35], v[188:191], v[64:79]
    ds_read_b64_tr_b16 v[32:33], v6 offset:8192
    ds_read_b64_tr_b16 v[34:35], v6 offset:8704
    v_mfma_f32_32x32x16_bf16 v[80:95], v[36:39], v[188:191], v[80:95]
    ds_read_b64_tr_b16 v[36:37], v7 offset:8192
    ds_read_b64_tr_b16 v[38:39], v7 offset:8704
    s_waitcnt lgkmcnt(10)
    v_mfma_f32_32x32x16_bf16 v[96:111], v[188:191], v[40:43], v[96:111]
    ds_read_b128 v[196:199], v3 offset:0
    ds_read_b64_tr_b16 v[40:41], v6 offset:2048
    ds_read_b64_tr_b16 v[42:43], v6 offset:2560
    v_mfma_f32_32x32x16_bf16 v[112:127], v[188:191], v[44:47], v[112:127]
    ds_read_b64_tr_b16 v[44:45], v7 offset:2048
    ds_read_b64_tr_b16 v[46:47], v7 offset:2560
    s_waitcnt lgkmcnt(9)
    v_mfma_f32_32x32x16_bf16 v[64:79], v[48:51], v[192:195], v[64:79]
    ds_read_b64_tr_b16 v[48:49], v6 offset:10240
    ds_read_b64_tr_b16 v[50:51], v6 offset:10752
    v_mfma_f32_32x32x16_bf16 v[80:95], v[52:55], v[192:195], v[80:95]
    ds_read_b64_tr_b16 v[52:53], v7 offset:10240
    ds_read_b64_tr_b16 v[54:55], v7 offset:10752
    s_waitcnt lgkmcnt(9)
    v_mfma_f32_32x32x16_bf16 v[96:111], v[192:195], v[32:35], v[96:111]
    ds_read_b128 v[200:203], v4 offset:0
    ds_read_b64_tr_b16 v[32:33], v6 offset:4096
    ds_read_b64_tr_b16 v[34:35], v6 offset:4608
    v_mfma_f32_32x32x16_bf16 v[112:127], v[192:195], v[36:39], v[112:127]
    ds_read_b64_tr_b16 v[36:37], v7 offset:4096
    ds_read_b64_tr_b16 v[38:39], v7 offset:4608
    s_waitcnt lgkmcnt(9)
    v_mfma_f32_32x32x16_bf16 v[64:79], v[40:43], v[196:199], v[64:79]
    ds_read_b64_tr_b16 v[40:41], v6 offset:12288
    ds_read_b64_tr_b16 v[42:43], v6 offset:12800
    v_mfma_f32_32x32x16_bf16 v[80:95], v[44:47], v[196:199], v[80:95]
    ds_read_b64_tr_b16 v[44:45], v7 offset:12288
    ds_read_b64_tr_b16 v[46:47], v7 offset:12800
    s_waitcnt lgkmcnt(9)
    v_mfma_f32_32x32x16_bf16 v[96:111], v[196:199], v[48:51], v[96:111]
    ds_read_b128 v[204:207], v5 offset:0
    ds_read_b64_tr_b16 v[48:49], v6 offset:6144
    ds_read_b64_tr_b16 v[50:51], v6 offset:6656
    v_mfma_f32_32x32x16_bf16 v[112:127], v[196:199], v[52:55], v[112:127]
    ds_read_b64_tr_b16 v[52:53], v7 offset:6144
    ds_read_b64_tr_b16 v[54:55], v7 offset:6656
    s_waitcnt lgkmcnt(9)
    v_mfma_f32_32x32x16_bf16 v[64:79], v[32:35], v[200:203], v[64:79]
    ds_read_b64_tr_b16 v[32:33], v6 offset:14336
    ds_read_b64_tr_b16 v[34:35], v6 offset:14848
    ds_read_b32 v254, v10 offset:276
    v_mfma_f32_32x32x16_bf16 v[80:95], v[36:39], v[200:203], v[80:95]
    ds_read_b64_tr_b16 v[36:37], v7 offset:14336
    ds_read_b64_tr_b16 v[38:39], v7 offset:14848
    s_waitcnt lgkmcnt(10)
    v_mfma_f32_32x32x16_bf16 v[96:111], v[200:203], v[40:43], v[96:111]
    s_waitcnt lgkmcnt(2)
    v_cmp_eq_u32 vcc, 2, v254
    s_cbranch_vccnz L_back_103
    s_mov_b32 s3, 0
L_slow_102:
    ds_read_b32 v254, v10 offset:276
    s_add_u32 s3, s3, 1
    s_cmp_gt_u32 s3, 60000
    s_cbranch_scc1 L_abort
    s_waitcnt lgkmcnt(0)
    v_cmp_ne_u32 vcc, 2, v254
    s_cbranch_vccnz L_slow_102
L_back_103:
    s_waitcnt vmcnt(0)
    ds_read_b128 v[208:211], v2 offset:16384
    ds_read_b64_tr_b16 v[40:41], v6 offset:16384
    ds_read_b64_tr_b16 v[42:43], v6 offset:16896
    v_mfma_f32_32x32x16_bf16 v[112:127], v[200:203], v[44:47], v[112:127]
    ds_read_b64_tr_b16 v[44:45], v7 offset:16384
    ds_read_b64_tr_b16 v[46:47], v7 offset:16896
    v_mfma_f32_32x32x16_bf16 v[64:79], v[48:51], v[204:207], v[64:79]
    ds_read_b64_tr_b16 v[48:49], v6 offset:24576
    ds_read_b64_tr_b16 v[50:51], v6 offset:25088
    v_mfma_f32_32x32x16_bf16 v[80:95], v[52:55], v[204:207], v[80:95]
    ds_read_b64_tr_b16 v[52:53], v7 offset:24576
    ds_read_b64_tr_b16 v[54:55], v7 offset:25088
    s_waitcnt lgkmcnt(9)
    v_mfma_f32_32x32x16_bf16 v[96:111], v[204:207], v[32:35], v[96:111]
    ds_read_b128 v[212:215], v3 offset:16384
    ds_read_b64_tr_b16 v[32:33], v6 offset:18432
    ds_read_b64_tr_b16 v[34:35], v6 offset:18944
    v_mfma_f32_32x32x16_bf16 v[112:127], v[204:207], v[36:39], v[112:127]
    ds_read_b64_tr_b16 v[36:37], v7 offset:18432
    ds_read_b64_tr_b16 v[38:39], v7 offset:18944
    s_waitcnt lgkmcnt(9)
    v_mfma_f32_32x32x16_bf16 v[64:79], v[40:43], v[208:211], v[64:79]
    ds_read_b64_tr_b16 v[40:41], v6 offset:26624
    ds_read_b64_tr_b16 v[42:43], v6 offset:27136
    v_mfma_f32_32x32x16_bf16 v[80:95], v[44:47], v[208:211], v[80:95]
    ds_read_b64_tr_b16 v[44:45], v7 offset:26624
    ds_read_b64_tr_b16 v[46:47], v7 offset:27136
    s_waitcnt lgkmcnt(9)
    v_mfma_f32_32x32x16_bf16 v[96:111], v[208:211], v[48:51], v[96:111]
    ds_read_b128 v[216:219], v4 offset:16384
    ds_read_b64_tr_b16 v[48:49], v6 offset:20480
    ds_read_b64_tr_b16 v[50:51], v6 offset:20992
    v_mfma_f32_32x32x16_bf16 v[112:127], v[208:211], v[52:55], v[112:127]
    ds_read_b64_tr_b16 v[52:53], v7 offset:20480
    ds_read_b64_tr_b16 v[54:55], v7 offset:20992
    s_waitcnt lgkmcnt(9)
    v_mfma_f32_32x32x16_bf16 v[64:79], v[32:35], v[212:215], v[64:79]
    ds_read_b64_tr_b16 v[32:33], v6 offset:28672
    ds_read_b64_tr_b16 v[34:35], v6 offset:29184
    v_mfma_f32_32x32x16_bf16 v[80:95], v[36:39], v[212:215], v[80:95]
    ds_read_b64_tr_b16 v[36:37], v7 offset:28672
    ds_read_b64_tr_b16 v[38:39], v7 offset:29184
    s_waitcnt lgkmcnt(9)
    v_mfma_f32_32x32x16_bf16 v[96:111], v[212:215], v[40:43], v[96:111]
    ds_read_b128 v[220:223], v5 offset:16384
    ds_read_b64_tr_b16 v[40:41], v6 offset:22528
    ds_read_b64_tr_b16 v[42:43], v6 offset:23040
    v_mfma_f32_32x32x16_bf16 v[112:127], v[212:215], v[44:47], v[112:127]
    ds_read_b64_tr_b16 v[44:45], v7 offset:22528
    ds_read_b64_tr_b16 v[46:47], v7 offset:23040
    s_waitcnt lgkmcnt(9)
    v_mfma_f32_32x32x16_bf16 v[64:79], v[48:51], v[216:219], v[64:79]
    ds_read_b64_tr_b16 v[48:49], v6 offset:30720
    ds_read_b64_tr_b16 v[50:51], v6 offset:31232
    ds_read_b32 v254, v10 offset:280
    v_mfma_f32_32x32x16_bf16 v[80:95], v[52:55], v[216:219], v[80:95]
    ds_read_b64_tr_b16 v[52:53], v7 offset:30720
    ds_read_b64_tr_b16 v[54:55], v7 offset:31232
    s_waitcnt lgkmcnt(10)
    v_mfma_f32_32x32x16_bf16 v[96:111], v[216:219], v[32:35], v[96:111]
    s_waitcnt lgkmcnt(2)
    v_cmp_eq_u32 vcc, 2, v254
    s_cbranch_vccnz L_back_105
    s_mov_b32 s3, 0
L_slow_104:
    ds_read_b32 v254, v10 offset:280
    s_add_u32 s3, s3, 1
    s_cmp_gt_u32 s3, 60000
    s_cbranch_scc1 L_abort
    s_waitcnt lgkmcnt(0)
    v_cmp_ne_u32 vcc, 2, v254
    s_cbranch_vccnz L_slow_104
L_back_105:
    ds_read_b128 v[224:227], v2 offset:32768
    ds_read_b64_tr_b16 v[32:33], v6 offset:32768
    ds_read_b64_tr_b16 v[34:35], v6 offset:33280
    v_mfma_f32_32x32x16_bf16 v[112:127], v[216:219], v[36:39], v[112:127]
    ds_read_b64_tr_b16 v[36:37], v7 offset:32768
    ds_read_b64_tr_b16 v[38:39], v7 offset:33280
    v_mfma_f32_32x32x16_bf16 v[64:79], v[40:43], v[220:223], v[64:79]
    ds_read_b64_tr_b16 v[40:41], v6 offset:40960
    ds_read_b64_tr_b16 v[42:43], v6 offset:41472
    v_mfma_f32_32x32x16_bf16 v[80:95], v[44:47], v[220:223], v[80:95]
    ds_read_b64_tr_b16 v[44:45], v7 offset:40960
    ds_read_b64_tr_b16 v[46:47], v7 offset:41472
    s_waitcnt lgkmcnt(9)
    v_mfma_f32_32x32x16_bf16 v[96:111], v[220:223], v[48:51], v[96:111]
    ds_read_b128 v[228:231], v3 offset:32768
    ds_read_b64_tr_b16 v[48:49], v6 offset:34816
    ds_read_b64_tr_b16 v[50:51], v6 offset:35328
    v_mfma_f32_32x32x16_bf16 v[112:127], v[220:223], v[52:55], v[112:127]
    ds_read_b64_tr_b16 v[52:53], v7 offset:34816
    ds_read_b64_tr_b16 v[54:55], v7 offset:35328
    s_waitcnt lgkmcnt(9)
    v_mfma_f32_32x32x16_bf16 v[64:79], v[32:35], v[224:227], v[64:79]
    ds_read_b64_tr_b16 v[32:33], v6 offset:43008
    ds_read_b64_tr_b16 v[34:35], v6 offset:43520
    v_mfma_f32_32x32x16_bf16 v[80:95], v[36:39], v[224:227], v[80:95]
    ds_read_b64_tr_b16 v[36:37], v7 offset:43008
    ds_read_b64_tr_b16 v[38:39], v7 offset:43520
    s_waitcnt lgkmcnt(9)
    v_mfma_f32_32x32x16_bf16 v[96:111], v[224:227], v[40:43], v[96:111]
    ds_read_b128 v[232:235], v4 offset:32768
    ds_read_b64_tr_b16 v[40:41], v6 offset:36864
    ds_read_b64_tr_b16 v[42:43], v6 offset:37376
    v_mfma_f32_32x32x16_bf16 v[112:127], v[224:227], v[44:47], v[112:127]
    ds_read_b64_tr_b16 v[44:45], v7 offset:36864
    ds_read_b64_tr_b16 v[46:47], v7 offset:37376
    s_waitcnt lgkmcnt(9)
    v_mfma_f32_32x32x16_bf16 v[64:79], v[48:51], v[228:231], v[64:79]
    ds_read_b64_tr_b16 v[48:49], v6 offset:45056
    ds_read_b64_tr_b16 v[50:51], v6 offset:45568
    v_mfma_f32_32x32x16_bf16 v[80:95], v[52:55], v[228:231], v[80:95]
    ds_read_b64_tr_b16 v[52:53], v7 offset:45056
    ds_read_b64_tr_b16 v[54:55], v7 offset:45568
    s_waitcnt lgkmcnt(9)
    v_mfma_f32_32x32x16_bf16 v[96:111], v[228:231], v[32:35], v[96:111]
    ds_read_b128 v[236:239], v5 offset:32768
    ds_read_b64_tr_b16 v[32:33], v6 offset:47104
    ds_read_b64_tr_b16 v[34:35], v6 offset:47616
    v_mfma_f32_32x32x16_bf16 v[112:127], v[228:231], v[36:39], v[112:127]
    ds_read_b64_tr_b16 v[36:37], v7 offset:47104
    ds_read_b64_tr_b16 v[38:39], v7 offset:47616
    s_waitcnt lgkmcnt(9)
    v_mfma_f32_32x32x16_bf16 v[64:79], v[40:43], v[232:235], v[64:79]
    ds_read_b64_tr_b16 v[40:41], v6 offset:38912
    ds_read_b64_tr_b16 v[42:43], v6 offset:39424
    v_mfma_f32_32x32x16_bf16 v[80:95], v[44:47], v[232:235], v[80:95]
    ds_read_b64_tr_b16 v[44:45], v7 offset:38912
    ds_read_b64_tr_b16 v[46:47], v7 offset:39424
    ds_add_u32 v13, v11 offset:32
    s_waitcnt lgkmcnt(10)
    v_mfma_f32_32x32x16_bf16 v[96:111], v[232:235], v[48:51], v[96:111]
    v_mfma_f32_32x32x16_bf16 v[112:127], v[232:235], v[52:55], v[112:127]
    s_waitcnt lgkmcnt(5)
    v_mfma_f32_32x32x16_bf16 v[96:111], v[236:239], v[32:35], v[96:111]
    v_mfma_f32_32x32x16_bf16 v[112:127], v[236:239], v[36:39], v[112:127]
    s_waitcnt lgkmcnt(1)
    v_mfma_f32_32x32x16_bf16 v[64:79], v[40:43], v[236:239], v[64:79]
    v_mfma_f32_32x32x16_bf16 v[80:95], v[44:47], v[236:239], v[80:95]
    s_mov_b32 s8, s22
    s_mov_b32 s9, s23
    s_mov_b32 s10, 16777216
    s_mov_b32 s11, 0x20000
    s_cmp_eq_u32 s25, 15
    s_cselect_b32 s10, 0, s10
    s_mul_i32 s36, s75, 28672
    s_lshl_b32 s29, s28, 10
    s_add_u32 s37, s36, s29
    s_add_u32 s37, s37, 2097152
    s_add_u32 s38, s37, 14336
    s_lshl_b32 s29, s28, 12
    s_add_u32 s36, s36, s29
    v_mul_f32 v64, s39, v64
    v_mul_f32_e64 v65, s39, v65
    v_cvt_pk_bf16_f32 v64, v64, v65
    v_mul_f32 v66, s39, v66
    v_mul_f32 v67, s39, v67
    v_cvt_pk_bf16_f32 v65, v66, v67
    v_mul_f32 v68, s39, v68
    v_mul_f32 v69, s39, v69
    v_cvt_pk_bf16_f32 v66, v68, v69
    v_mul_f32 v70, s39, v70
    v_mul_f32 v71, s39, v71
    v_cvt_pk_bf16_f32 v67, v70, v71
    v_mul_f32 v72, s39, v72
    v_mul_f32 v73, s39, v73
    v_cvt_pk_bf16_f32 v68, v72, v73
    v_mul_f32 v74, s39, v74
    v_mul_f32 v75, s39, v75
    v_cvt_pk_bf16_f32 v69, v74, v75
    v_mul_f32 v76, s39, v76
    v_mul_f32 v77, s39, v77
    v_cvt_pk_bf16_f32 v70, v76, v77
    v_mul_f32 v78, s39, v78
    v_mul_f32 v79, s39, v79
    v_cvt_pk_bf16_f32 v71, v78, v79
    v_permlane32_swap_b32 v64, v66
    v_permlane32_swap_b32 v65, v67
    v_permlane32_swap_b32 v68, v70
    v_permlane32_swap_b32 v69, v71
    buffer_store_dwordx4 v[64:67], v1, s[8:11], s36 offen offset:0 sc1
    buffer_store_dwordx4 v[68:71], v1, s[8:11], s36 offen offset:1024 sc1
    v_mul_f32 v80, s39, v80
    v_mul_f32 v81, s39, v81
    v_cvt_pk_bf16_f32 v80, v80, v81
    v_mul_f32 v82, s39, v82
    v_mul_f32 v83, s39, v83
    v_cvt_pk_bf16_f32 v81, v82, v83
    v_mul_f32 v84, s39, v84
    v_mul_f32 v85, s39, v85
    v_cvt_pk_bf16_f32 v82, v84, v85
    v_mul_f32 v86, s39, v86
    v_mul_f32 v87, s39, v87
    v_cvt_pk_bf16_f32 v83, v86, v87
    v_mul_f32 v88, s39, v88
    v_mul_f32 v89, s39, v89
    v_cvt_pk_bf16_f32 v84, v88, v89
    v_mul_f32 v90, s39, v90
    v_mul_f32 v91, s39, v91
    v_cvt_pk_bf16_f32 v85, v90, v91
    v_mul_f32 v92, s39, v92
    v_mul_f32 v93, s39, v93
    v_cvt_pk_bf16_f32 v86, v92, v93
    v_mul_f32 v94, s39, v94
    v_mul_f32 v95, s39, v95
    v_cvt_pk_bf16_f32 v87, v94, v95
    v_permlane32_swap_b32 v80, v82
    v_permlane32_swap_b32 v81, v83
    v_permlane32_swap_b32 v84, v86
    v_permlane32_swap_b32 v85, v87
    buffer_store_dwordx4 v[80:83], v1, s[8:11], s36 offen offset:2048 sc1
    buffer_store_dwordx4 v[84:87], v1, s[8:11], s36 offen offset:3072 sc1
    v_cvt_pk_bf16_f32 v16, v96, v97
    v_cvt_pk_bf16_f32 v17, v98, v99
    v_cvt_pk_bf16_f32 v18, v100, v101
    v_cvt_pk_bf16_f32 v19, v102, v103
    v_cvt_pk_bf16_f32 v20, v104, v105
    v_cvt_pk_bf16_f32 v21, v106, v107
    v_cvt_pk_bf16_f32 v22, v108, v109
    v_cvt_pk_bf16_f32 v23, v110, v111
    v_cvt_pk_bf16_f32 v24, v112, v113
    v_cvt_pk_bf16_f32 v25, v114, v115
    v_cvt_pk_bf16_f32 v26, v116, v117
    v_cvt_pk_bf16_f32 v27, v118, v119
    v_cvt_pk_bf16_f32 v28, v120, v121
    v_cvt_pk_bf16_f32 v29, v122, v123
    v_cvt_pk_bf16_f32 v30, v124, v125
    v_cvt_pk_bf16_f32 v31, v126, v127
    v_lshrrev_b32_e64 v250, 5, v0
    v_mul_u32_u24 v250, 6656, v250
    v_add_u32_e64 v250, v250, v1
    buffer_store_dwordx4 v[16:19], v250, s[8:11], s37 offen offset:0 sc1
    buffer_store_dwordx4 v[20:23], v250, s[8:11], s38 offen offset:0 sc1
    buffer_store_dwordx4 v[24:27], v250, s[8:11], s37 offen offset:512 sc1
    buffer_store_dwordx4 v[28:31], v250, s[8:11], s38 offen offset:512 sc1
    ds_add_u32 v13, v11 offset:240
    s_waitcnt lgkmcnt(0)
    s_mov_b32 s3, 0
L_wl_118:
    ds_read_b32 v252, v10 offset:284
    s_add_u32 s3, s3, 1
    s_cmp_gt_u32 s3, 60000
    s_cbranch_scc1 L_abort
    s_waitcnt lgkmcnt(0)
    v_cmp_ne_u32 vcc, 2, v252
    s_cbranch_vccnz L_wl_118
    ds_read_b64_tr_b16 v[48:49], v8 offset:16384
    ds_read_b64_tr_b16 v[50:51], v8 offset:16640
    ds_read_b64_tr_b16 v[52:53], v8 offset:17408
    ds_read_b64_tr_b16 v[54:55], v8 offset:17664
    ds_read_b64_tr_b16 v[32:33], v8 offset:18432
    ds_read_b64_tr_b16 v[34:35], v8 offset:18688
    ds_read_b32 v254, v10 offset:292
    s_waitcnt lgkmcnt(3)
    v_mfma_f32_32x32x16_bf16 v[96:111], v[48:51], v[128:131], 0
    ds_read_b64_tr_b16 v[36:37], v8 offset:19456
    ds_read_b64_tr_b16 v[38:39], v8 offset:19712
    s_waitcnt lgkmcnt(2)
    v_cmp_ne_u32 vcc, 2, v254
    s_cbranch_vccnz L_slow_120
L_back_121:
    ds_read_b64_tr_b16 v[40:41], v8 offset:20480
    ds_read_b64_tr_b16 v[42:43], v8 offset:20736
    ds_read_b64_tr_b16 v[44:45], v8 offset:21504
    ds_read_b64_tr_b16 v[46:47], v8 offset:21760
    ds_read_b64_tr_b16 v[48:49], v8 offset:22528
    ds_read_b64_tr_b16 v[50:51], v8 offset:22784
    v_mfma_f32_32x32x16_bf16 v[96:111], v[52:55], v[132:135], v[96:111]
    ds_read_b64_tr_b16 v[52:53], v8 offset:23552
    ds_read_b64_tr_b16 v[54:55], v8 offset:23808
    s_waitcnt lgkmcnt(8)
    v_mfma_f32_32x32x16_bf16 v[96:111], v[32:35], v[136:139], v[96:111]
    ds_read_b64_tr_b16 v[32:33], v8 offset:24576
    ds_read_b64_tr_b16 v[34:35], v8 offset:24832
    v_mfma_f32_32x32x16_bf16 v[96:111], v[36:39], v[140:143], v[96:111]
    ds_read_b64_tr_b16 v[36:37], v8 offset:25600
    ds_read_b64_tr_b16 v[38:39], v8 offset:25856
    s_waitcnt lgkmcnt(8)
    v_mfma_f32_32x32x16_bf16 v[96:111], v[40:43], v[144:147], v[96:111]
    ds_read_b64_tr_b16 v[40:41], v8 offset:26624
    ds_read_b64_tr_b16 v[42:43], v8 offset:26880
    ds_read_b32 v254, v10 offset:300
    v_mfma_f32_32x32x16_bf16 v[96:111], v[44:47], v[148:151], v[96:111]
    ds_read_b64_tr_b16 v[44:45], v8 offset:27648
    ds_read_b64_tr_b16 v[46:47], v8 offset:27904
    s_waitcnt lgkmcnt(9)
    v_mfma_f32_32x32x16_bf16 v[96:111], v[48:51], v[152:155], v[96:111]
    s_waitcnt lgkmcnt(2)
    v_cmp_ne_u32 vcc, 2, v254
    s_cbranch_vccnz L_slow_122
L_back_123:
    ds_read_b64_tr_b16 v[48:49], v8 offset:28672
    ds_read_b64_tr_b16 v[50:51], v8 offset:28928
    v_mfma_f32_32x32x16_bf16 v[96:111], v[52:55], v[156:159], v[96:111]
    ds_read_b64_tr_b16 v[52:53], v8 offset:29696
    ds_read_b64_tr_b16 v[54:55], v8 offset:29952
    v_mfma_f32_32x32x16_bf16 v[96:111], v[32:35], v[160:163], v[96:111]
    ds_read_b64_tr_b16 v[32:33], v8 offset:30720
    ds_read_b64_tr_b16 v[34:35], v8 offset:30976
    v_mfma_f32_32x32x16_bf16 v[96:111], v[36:39], v[164:167], v[96:111]
    ds_read_b64_tr_b16 v[36:37], v8 offset:31744
    ds_read_b64_tr_b16 v[38:39], v8 offset:32000
    s_waitcnt lgkmcnt(8)
    v_mfma_f32_32x32x16_bf16 v[96:111], v[40:43], v[168:171], v[96:111]
    ds_read_b64_tr_b16 v[40:41], v8 offset:32768
    ds_read_b64_tr_b16 v[42:43], v8 offset:33024
    v_mfma_f32_32x32x16_bf16 v[96:111], v[44:47], v[172:175], v[96:111]
    ds_read_b64_tr_b16 v[44:45], v8 offset:33792
    ds_read_b64_tr_b16 v[46:47], v8 offset:34048
    s_waitcnt lgkmcnt(8)
    v_mfma_f32_32x32x16_bf16 v[96:111], v[48:51], v[176:179], v[96:111]
    ds_read_b64_tr_b16 v[48:49], v8 offset:34816
    ds_read_b64_tr_b16 v[50:51], v8 offset:35072
    ds_read_b32 v254, v10 offset:308
    v_mfma_f32_32x32x16_bf16 v[96:111], v[52:55], v[180:183], v[96:111]
    ds_read_b64_tr_b16 v[52:53], v8 offset:35840
    ds_read_b64_tr_b16 v[54:55], v8 offset:36096
    s_waitcnt lgkmcnt(9)
    v_mfma_f32_32x32x16_bf16 v[96:111], v[32:35], v[184:187], v[96:111]
    s_waitcnt lgkmcnt(2)
    v_cmp_ne_u32 vcc, 2, v254
    s_cbranch_vccnz L_slow_124
L_back_125:
    ds_read_b64_tr_b16 v[32:33], v8 offset:36864
    ds_read_b64_tr_b16 v[34:35], v8 offset:37120
    v_mfma_f32_32x32x16_bf16 v[96:111], v[36:39], v[188:191], v[96:111]
    ds_read_b64_tr_b16 v[36:37], v8 offset:37888
    ds_read_b64_tr_b16 v[38:39], v8 offset:38144
    v_mfma_f32_32x32x16_bf16 v[96:111], v[40:43], v[192:195], v[96:111]
    s_waitcnt vmcnt(4)
    ds_add_u32 v13, v11 offset:64
    ds_read_b64_tr_b16 v[40:41], v8 offset:38912
    ds_read_b64_tr_b16 v[42:43], v8 offset:39168
    v_mfma_f32_32x32x16_bf16 v[96:111], v[44:47], v[196:199], v[96:111]
    ds_read_b64_tr_b16 v[44:45], v8 offset:39936
    ds_read_b64_tr_b16 v[46:47], v8 offset:40192
    s_waitcnt lgkmcnt(9)
    v_mfma_f32_32x32x16_bf16 v[96:111], v[48:51], v[200:203], v[96:111]
    ds_read_b64_tr_b16 v[48:49], v8 offset:0
    ds_read_b64_tr_b16 v[50:51], v8 offset:256
    v_mfma_f32_32x32x16_bf16 v[96:111], v[52:55], v[204:207], v[96:111]
    ds_read_b64_tr_b16 v[52:53], v8 offset:1024
    ds_read_b64_tr_b16 v[54:55], v8 offset:1280
    s_waitcnt lgkmcnt(9)
    v_mfma_f32_32x32x16_bf16 v[96:111], v[32:35], v[208:211], v[96:111]
    ds_read_b64_tr_b16 v[32:33], v8 offset:2048
    ds_read_b64_tr_b16 v[34:35], v8 offset:2304
    ds_read_b32 v254, v10 offset:312
    v_mfma_f32_32x32x16_bf16 v[96:111], v[36:39], v[212:215], v[96:111]
    ds_read_b64_tr_b16 v[36:37], v8 offset:3072
    ds_read_b64_tr_b16 v[38:39], v8 offset:3328
    ds_add_u32 v13, v11 offset:144
    s_waitcnt lgkmcnt(10)
    v_mfma_f32_32x32x16_bf16 v[96:111], v[40:43], v[216:219], v[96:111]
    s_waitcnt lgkmcnt(3)
    v_cmp_ne_u32 vcc, 2, v254
    s_cbranch_vccnz L_slow_126
L_back_127:
    ds_read_b64_tr_b16 v[40:41], v9 offset:4096
    ds_read_b64_tr_b16 v[42:43], v9 offset:4352
    v_mfma_f32_32x32x16_bf16 v[96:111], v[44:47], v[220:223], v[96:111]
    ds_read_b64_tr_b16 v[44:45], v9 offset:5120
    ds_read_b64_tr_b16 v[46:47], v9 offset:5376
    v_mfma_f32_32x32x16_bf16 v[96:111], v[48:51], v[224:227], v[96:111]
    ds_read_b64_tr_b16 v[48:49], v9 offset:6144
    ds_read_b64_tr_b16 v[50:51], v9 offset:6400
    ds_read_b32 v254, v10 offset:320
    v_mfma_f32_32x32x16_bf16 v[96:111], v[52:55], v[228:231], v[96:111]
    ds_read_b64_tr_b16 v[52:53], v9 offset:7168
    ds_read_b64_tr_b16 v[54:55], v9 offset:7424
    s_waitcnt lgkmcnt(10)
    v_mfma_f32_32x32x16_bf16 v[96:111], v[32:35], v[232:235], v[96:111]
    s_waitcnt vmcnt(0)
    ds_add_u32 v13, v11 offset:80
    s_waitcnt lgkmcnt(3)
    v_cmp_ne_u32 vcc, 2, v254
    s_cbranch_vccnz L_slow_128
L_back_129:
    ds_read_b64_tr_b16 v[32:33], v9 offset:8192
    ds_read_b64_tr_b16 v[34:35], v9 offset:8448
    v_mfma_f32_32x32x16_bf16 v[96:111], v[36:39], v[236:239], v[96:111]
    ds_read_b64_tr_b16 v[36:37], v9 offset:9216
    ds_read_b64_tr_b16 v[38:39], v9 offset:9472
    v_mfma_f32_32x32x16_bf16 v[112:127], v[40:43], v[128:131], 0
    ds_read_b64_tr_b16 v[40:41], v9 offset:10240
    ds_read_b64_tr_b16 v[42:43], v9 offset:10496
    v_mfma_f32_32x32x16_bf16 v[112:127], v[44:47], v[132:135], v[112:127]
    ds_read_b64_tr_b16 v[44:45], v9 offset:11264
    ds_read_b64_tr_b16 v[46:47], v9 offset:11520
    s_waitcnt lgkmcnt(9)
    v_mfma_f32_32x32x16_bf16 v[112:127], v[48:51], v[136:139], v[112:127]
    ds_read_b64_tr_b16 v[48:49], v9 offset:12288
    ds_read_b64_tr_b16 v[50:51], v9 offset:12544
    v_mfma_f32_32x32x16_bf16 v[112:127], v[52:55], v[140:143], v[112:127]
    ds_read_b64_tr_b16 v[52:53], v9 offset:13312
    ds_read_b64_tr_b16 v[54:55], v9 offset:13568
    s_waitcnt lgkmcnt(8)
    v_mfma_f32_32x32x16_bf16 v[112:127], v[32:35], v[144:147], v[112:127]
    v_cvt_pk_bf16_f32 v16, v96, v97
    v_cvt_pk_bf16_f32 v17, v98, v99
    ds_read_b64_tr_b16 v[32:33], v9 offset:14336
    ds_read_b64_tr_b16 v[34:35], v9 offset:14592
    ds_read_b32 v254, v10 offset:328
    v_mfma_f32_32x32x16_bf16 v[112:127], v[36:39], v[148:151], v[112:127]
    v_cvt_pk_bf16_f32 v18, v100, v101
    v_cvt_pk_bf16_f32 v19, v102, v103
    ds_read_b64_tr_b16 v[36:37], v9 offset:15360
    ds_read_b64_tr_b16 v[38:39], v9 offset:15616
    s_waitcnt lgkmcnt(9)
    v_mfma_f32_32x32x16_bf16 v[112:127], v[40:43], v[152:155], v[112:127]
    v_cvt_pk_bf16_f32 v20, v104, v105
    v_cvt_pk_bf16_f32 v21, v106, v107
    s_waitcnt lgkmcnt(2)
    v_cmp_ne_u32 vcc, 2, v254
    s_cbranch_vccnz L_slow_130
L_back_131:
    v_subrev_u32 v9, 65536, v9
    ds_read_b64_tr_b16 v[40:41], v9 offset:0
    ds_read_b64_tr_b16 v[42:43], v9 offset:256
    v_mfma_f32_32x32x16_bf16 v[112:127], v[44:47], v[156:159], v[112:127]
    v_cvt_pk_bf16_f32 v22, v108, v109
    v_cvt_pk_bf16_f32 v23, v110, v111
    ds_read_b64_tr_b16 v[44:45], v9 offset:1024
    ds_read_b64_tr_b16 v[46:47], v9 offset:1280
    v_mfma_f32_32x32x16_bf16 v[112:127], v[48:51], v[160:163], v[112:127]
    ds_write_b128 v15, v[16:19] offset:0
    ds_write_b128 v15, v[20:23] offset:1024
    ds_read_b64_tr_b16 v[48:49], v9 offset:2048
    ds_read_b64_tr_b16 v[50:51], v9 offset:2304
    v_mfma_f32_32x32x16_bf16 v[112:127], v[52:55], v[164:167], v[112:127]
    ds_add_u32 v13, v11 offset:96
    ds_read_b64_tr_b16 v[52:53], v9 offset:3072
    ds_read_b64_tr_b16 v[54:55], v9 offset:3328
    s_waitcnt lgkmcnt(11)
    v_mfma_f32_32x32x16_bf16 v[112:127], v[32:35], v[168:171], v[112:127]
    ds_read_b64_tr_b16 v[32:33], v9 offset:4096
    ds_read_b64_tr_b16 v[34:35], v9 offset:4352
    v_mfma_f32_32x32x16_bf16 v[112:127], v[36:39], v[172:175], v[112:127]
    ds_read_b64_tr_b16 v[36:37], v9 offset:5120
    ds_read_b64_tr_b16 v[38:39], v9 offset:5376
    s_waitcnt lgkmcnt(11)
    v_mfma_f32_32x32x16_bf16 v[112:127], v[40:43], v[176:179], v[112:127]
    ds_read_b64_tr_b16 v[40:41], v9 offset:6144
    ds_read_b64_tr_b16 v[42:43], v9 offset:6400
    ds_read_b32 v254, v10 offset:336
    v_mfma_f32_32x32x16_bf16 v[112:127], v[44:47], v[180:183], v[112:127]
    ds_read_b64_tr_b16 v[44:45], v9 offset:7168
    ds_read_b64_tr_b16 v[46:47], v9 offset:7424
    s_waitcnt lgkmcnt(9)
    v_mfma_f32_32x32x16_bf16 v[112:127], v[48:51], v[184:187], v[112:127]
    s_waitcnt lgkmcnt(2)
    v_cmp_ne_u32 vcc, 2, v254
    s_cbranch_vccnz L_slow_132
L_back_133:
    ds_read_b64_tr_b16 v[48:49], v9 offset:8192
    ds_read_b64_tr_b16 v[50:51], v9 offset:8448
    v_mfma_f32_32x32x16_bf16 v[112:127], v[52:55], v[188:191], v[112:127]
    ds_read_b64_tr_b16 v[52:53], v9 offset:9216
    ds_read_b64_tr_b16 v[54:55], v9 offset:9472
    v_mfma_f32_32x32x16_bf16 v[112:127], v[32:35], v[192:195], v[112:127]
    ds_read_b64_tr_b16 v[32:33], v9 offset:10240
    ds_read_b64_tr_b16 v[34:35], v9 offset:10496
    v_mfma_f32_32x32x16_bf16 v[112:127], v[36:39], v[196:199], v[112:127]
    ds_read_b64_tr_b16 v[36:37], v9 offset:11264
    ds_read_b64_tr_b16 v[38:39], v9 offset:11520
    s_waitcnt lgkmcnt(8)
    v_mfma_f32_32x32x16_bf16 v[112:127], v[40:43], v[200:203], v[112:127]
    ds_read_b64_tr_b16 v[40:41], v9 offset:12288
    ds_read_b64_tr_b16 v[42:43], v9 offset:12544
    v_mfma_f32_32x32x16_bf16 v[112:127], v[44:47], v[204:207], v[112:127]
    ds_read_b64_tr_b16 v[44:45], v9 offset:13312
    ds_read_b64_tr_b16 v[46:47], v9 offset:13568
    s_waitcnt lgkmcnt(8)
    v_mfma_f32_32x32x16_bf16 v[112:127], v[48:51], v[208:211], v[112:127]
    ds_read_b64_tr_b16 v[48:49], v9 offset:14336
    ds_read_b64_tr_b16 v[50:51], v9 offset:14592
    v_mfma_f32_32x32x16_bf16 v[112:127], v[52:55], v[212:215], v[112:127]
    ds_read_b64_tr_b16 v[52:53], v9 offset:15360
    ds_read_b64_tr_b16 v[54:55], v9 offset:15616
    ds_add_u32 v13, v11 offset:48
    s_waitcnt lgkmcnt(9)
    v_mfma_f32_32x32x16_bf16 v[112:127], v[32:35], v[216:219], v[112:127]
    v_mfma_f32_32x32x16_bf16 v[112:127], v[36:39], v[220:223], v[112:127]
    s_waitcnt lgkmcnt(5)
    v_mfma_f32_32x32x16_bf16 v[112:127], v[40:43], v[224:227], v[112:127]
    v_mfma_f32_32x32x16_bf16 v[112:127], v[44:47], v[228:231], v[112:127]
    s_waitcnt lgkmcnt(1)
    v_mfma_f32_32x32x16_bf16 v[112:127], v[48:51], v[232:235], v[112:127]
    v_mfma_f32_32x32x16_bf16 v[112:127], v[52:55], v[236:239], v[112:127]
    s_nop 11
    v_cvt_pk_bf16_f32 v240, v112, v113
    v_cvt_pk_bf16_f32 v241, v114, v115
    v_cvt_pk_bf16_f32 v242, v116, v117
    v_cvt_pk_bf16_f32 v243, v118, v119
    v_cvt_pk_bf16_f32 v244, v120, v121
    v_cvt_pk_bf16_f32 v245, v122, v123
    v_cvt_pk_bf16_f32 v246, v124, v125
    v_cvt_pk_bf16_f32 v247, v126, v127
    v_and_b32 v240, v240, v248
    v_and_b32 v241, v241, v248
    v_and_b32 v246, v246, v249
    v_and_b32 v247, v247, v249
    s_branch L_attn
L_cY:
    s_waitcnt lgkmcnt(0)
    s_mov_b32 s3, 0
L_wl_134:
    ds_read_b32 v252, v10 offset:256
    s_add_u32 s3, s3, 1
    s_cmp_gt_u32 s3, 60000
    s_cbranch_scc1 L_abort
    s_waitcnt lgkmcnt(0)
    v_cmp_ne_u32 vcc, 2, v252
    s_cbranch_vccnz L_wl_134
    ds_read_b128 v[128:131], v2 offset:0
    ds_read_b64_tr_b16 v[32:33], v6 offset:0
    ds_read_b64_tr_b16 v[34:35], v6 offset:512
    ds_read_b64_tr_b16 v[36:37], v7 offset:0
    ds_read_b64_tr_b16 v[38:39], v7 offset:512
    ds_read_b64_tr_b16 v[40:41], v6 offset:8192
    ds_read_b64_tr_b16 v[42:43], v6 offset:8704
    ds_read_b64_tr_b16 v[44:45], v7 offset:8192
    ds_read_b64_tr_b16 v[46:47], v7 offset:8704
    s_waitcnt lgkmcnt(4)
    v_mfma_f32_32x32x16_bf16 v[64:79], v[128:131], v[32:35], 0
    ds_read_b128 v[132:135], v3 offset:0
    ds_read_b64_tr_b16 v[48:49], v6 offset:2048
    ds_read_b64_tr_b16 v[50:51], v6 offset:2560
    ds_read_b64_tr_b16 v[52:53], v7 offset:2048
    ds_read_b64_tr_b16 v[54:55], v7 offset:2560
    ds_read_b64_tr_b16 v[32:33], v6 offset:10240
    ds_read_b64_tr_b16 v[34:35], v6 offset:10752
    v_mfma_f32_32x32x16_bf16 v[80:95], v[128:131], v[36:39], 0
    ds_read_b64_tr_b16 v[36:37], v7 offset:10240
    ds_read_b64_tr_b16 v[38:39], v7 offset:10752
    s_waitcnt lgkmcnt(9)
    v_mfma_f32_32x32x16_bf16 v[96:111], v[128:131], v[40:43], 0
    ds_read_b128 v[136:139], v4 offset:0
    ds_read_b64_tr_b16 v[40:41], v6 offset:4096
    ds_read_b64_tr_b16 v[42:43], v6 offset:4608
    v_mfma_f32_32x32x16_bf16 v[112:127], v[128:131], v[44:47], 0
    ds_read_b64_tr_b16 v[44:45], v7 offset:4096
    ds_read_b64_tr_b16 v[46:47], v7 offset:4608
    s_waitcnt lgkmcnt(9)
    v_mfma_f32_32x32x16_bf16 v[64:79], v[132:135], v[48:51], v[64:79]
    ds_read_b64_tr_b16 v[48:49], v6 offset:12288
    ds_read_b64_tr_b16 v[50:51], v6 offset:12800
    v_mfma_f32_32x32x16_bf16 v[80:95], v[132:135], v[52:55], v[80:95]
    ds_read_b64_tr_b16 v[52:53], v7 offset:12288
    ds_read_b64_tr_b16 v[54:55], v7 offset:12800
    s_waitcnt lgkmcnt(9)
    v_mfma_f32_32x32x16_bf16 v[96:111], v[132:135], v[32:35], v[96:111]
    ds_read_b128 v[140:143], v5 offset:0
    ds_read_b64_tr_b16 v[32:33], v6 offset:6144
    ds_read_b64_tr_b16 v[34:35], v6 offset:6656
    v_mfma_f32_32x32x16_bf16 v[112:127], v[132:135], v[36:39], v[112:127]
    ds_read_b64_tr_b16 v[36:37], v7 offset:6144
    ds_read_b64_tr_b16 v[38:39], v7 offset:6656
    s_waitcnt lgkmcnt(9)
    v_mfma_f32_32x32x16_bf16 v[64:79], v[136:139], v[40:43], v[64:79]
    ds_read_b64_tr_b16 v[40:41], v6 offset:14336
    ds_read_b64_tr_b16 v[42:43], v6 offset:14848
    ds_read_b32 v254, v10 offset:260
    v_mfma_f32_32x32x16_bf16 v[80:95], v[136:139], v[44:47], v[80:95]
    ds_read_b64_tr_b16 v[44:45], v7 offset:14336
    ds_read_b64_tr_b16 v[46:47], v7 offset:14848
    ds_add_u32 v13, v11 offset:0
    s_waitcnt lgkmcnt(11)
    v_mfma_f32_32x32x16_bf16 v[96:111], v[136:139], v[48:51], v[96:111]
    s_waitcnt lgkmcnt(3)
    v_cmp_eq_u32 vcc, 2, v254
    s_cbranch_vccnz L_back_137
    s_mov_b32 s3, 0
L_slow_136:
    ds_read_b32 v254, v10 offset:260
    s_add_u32 s3, s3, 1
    s_cmp_gt_u32 s3, 60000
    s_cbranch_scc1 L_abort
    s_waitcnt lgkmcnt(0)
    v_cmp_ne_u32 vcc, 2, v254
    s_cbranch_vccnz L_slow_136
L_back_137:
    ds_read_b128 v[144:147], v2 offset:16384
    ds_read_b64_tr_b16 v[48:49], v6 offset:16384
    ds_read_b64_tr_b16 v[50:51], v6 offset:16896
    v_mfma_f32_32x32x16_bf16 v[112:127], v[136:139], v[52:55], v[112:127]
    ds_read_b64_tr_b16 v[52:53], v7 offset:16384
    ds_read_b64_tr_b16 v[54:55], v7 offset:16896
    v_mfma_f32_32x32x16_bf16 v[64:79], v[140:143], v[32:35], v[64:79]
    ds_read_b64_tr_b16 v[32:33], v6 offset:24576
    ds_read_b64_tr_b16 v[34:35], v6 offset:25088
    v_mfma_f32_32x32x16_bf16 v[80:95], v[140:143], v[36:39], v[80:95]
    ds_read_b64_tr_b16 v[36:37], v7 offset:24576
    ds_read_b64_tr_b16 v[38:39], v7 offset:25088
    s_waitcnt lgkmcnt(10)
    v_mfma_f32_32x32x16_bf16 v[96:111], v[140:143], v[40:43], v[96:111]
    ds_read_b128 v[148:151], v3 offset:16384
    ds_read_b64_tr_b16 v[40:41], v6 offset:18432
    ds_read_b64_tr_b16 v[42:43], v6 offset:18944
    v_mfma_f32_32x32x16_bf16 v[112:127], v[140:143], v[44:47], v[112:127]
    ds_read_b64_tr_b16 v[44:45], v7 offset:18432
    ds_read_b64_tr_b16 v[46:47], v7 offset:18944
    s_waitcnt lgkmcnt(9)
    v_mfma_f32_32x32x16_bf16 v[64:79], v[144:147], v[48:51], v[64:79]
    ds_read_b64_tr_b16 v[48:49], v6 offset:26624
    ds_read_b64_tr_b16 v[50:51], v6 offset:27136
    v_mfma_f32_32x32x16_bf16 v[80:95], v[144:147], v[52:55], v[80:95]
    ds_read_b64_tr_b16 v[52:53], v7 offset:26624
    ds_read_b64_tr_b16 v[54:55], v7 offset:27136
    s_waitcnt lgkmcnt(9)
    v_mfma_f32_32x32x16_bf16 v[96:111], v[144:147], v[32:35], v[96:111]
    ds_read_b128 v[152:155], v4 offset:16384
    ds_read_b64_tr_b16 v[32:33], v6 offset:20480
    ds_read_b64_tr_b16 v[34:35], v6 offset:20992
    v_mfma_f32_32x32x16_bf16 v[112:127], v[144:147], v[36:39], v[112:127]
    ds_read_b64_tr_b16 v[36:37], v7 offset:20480
    ds_read_b64_tr_b16 v[38:39], v7 offset:20992
    s_waitcnt lgkmcnt(9)
    v_mfma_f32_32x32x16_bf16 v[64:79], v[148:151], v[40:43], v[64:79]
    ds_read_b64_tr_b16 v[40:41], v6 offset:28672
    ds_read_b64_tr_b16 v[42:43], v6 offset:29184
    v_mfma_f32_32x32x16_bf16 v[80:95], v[148:151], v[44:47], v[80:95]
    ds_read_b64_tr_b16 v[44:45], v7 offset:28672
    ds_read_b64_tr_b16 v[46:47], v7 offset:29184
    s_waitcnt lgkmcnt(9)
    v_mfma_f32_32x32x16_bf16 v[96:111], v[148:151], v[48:51], v[96:111]
    ds_read_b128 v[156:159], v5 offset:16384
    ds_read_b64_tr_b16 v[48:49], v6 offset:22528
    ds_read_b64_tr_b16 v[50:51], v6 offset:23040
    v_mfma_f32_32x32x16_bf16 v[112:127], v[148:151], v[52:55], v[112:127]
    ds_read_b64_tr_b16 v[52:53], v7 offset:22528
    ds_read_b64_tr_b16 v[54:55], v7 offset:23040
    s_waitcnt lgkmcnt(9)
    v_mfma_f32_32x32x16_bf16 v[64:79], v[152:155], v[32:35], v[64:79]
    ds_read_b64_tr_b16 v[32:33], v6 offset:30720
    ds_read_b64_tr_b16 v[34:35], v6 offset:31232
    ds_read_b32 v254, v10 offset:264
    v_mfma_f32_32x32x16_bf16 v[80:95], v[152:155], v[36:39], v[80:95]
    ds_read_b64_tr_b16 v[36:37], v7 offset:30720
    ds_read_b64_tr_b16 v[38:39], v7 offset:31232
    ds_add_u32 v13, v11 offset:0
    s_waitcnt lgkmcnt(11)
    v_mfma_f32_32x32x16_bf16 v[96:111], v[152:155], v[40:43], v[96:111]
    s_waitcnt lgkmcnt(3)
    v_cmp_eq_u32 vcc, 2, v254
    s_cbranch_vccnz L_back_139
    s_mov_b32 s3, 0
L_slow_138:
    ds_read_b32 v254, v10 offset:264
    s_add_u32 s3, s3, 1
    s_cmp_gt_u32 s3, 60000
    s_cbranch_scc1 L_abort
    s_waitcnt lgkmcnt(0)
    v_cmp_ne_u32 vcc, 2, v254
    s_cbranch_vccnz L_slow_138
L_back_139:
    ds_read_b128 v[160:163], v2 offset:32768
    ds_read_b64_tr_b16 v[40:41], v6 offset:32768
    ds_read_b64_tr_b16 v[42:43], v6 offset:33280
    v_mfma_f32_32x32x16_bf16 v[112:127], v[152:155], v[44:47], v[112:127]
    ds_read_b64_tr_b16 v[44:45], v7 offset:32768
    ds_read_b64_tr_b16 v[46:47], v7 offset:33280
    v_mfma_f32_32x32x16_bf16 v[64:79], v[156:159], v[48:51], v[64:79]
    ds_read_b64_tr_b16 v[48:49], v6 offset:40960
    ds_read_b64_tr_b16 v[50:51], v6 offset:41472
    v_mfma_f32_32x32x16_bf16 v[80:95], v[156:159], v[52:55], v[80:95]
    ds_read_b64_tr_b16 v[52:53], v7 offset:40960
    ds_read_b64_tr_b16 v[54:55], v7 offset:41472
    s_waitcnt lgkmcnt(10)
    v_mfma_f32_32x32x16_bf16 v[96:111], v[156:159], v[32:35], v[96:111]
    ds_read_b128 v[164:167], v3 offset:32768
    ds_read_b64_tr_b16 v[32:33], v6 offset:34816
    ds_read_b64_tr_b16 v[34:35], v6 offset:35328
    v_mfma_f32_32x32x16_bf16 v[112:127], v[156:159], v[36:39], v[112:127]
    ds_read_b64_tr_b16 v[36:37], v7 offset:34816
    ds_read_b64_tr_b16 v[38:39], v7 offset:35328
    s_waitcnt lgkmcnt(9)
    v_mfma_f32_32x32x16_bf16 v[64:79], v[160:163], v[40:43], v[64:79]
    ds_read_b64_tr_b16 v[40:41], v6 offset:43008
    ds_read_b64_tr_b16 v[42:43], v6 offset:43520
    v_mfma_f32_32x32x16_bf16 v[80:95], v[160:163], v[44:47], v[80:95]
    ds_read_b64_tr_b16 v[44:45], v7 offset:43008
    ds_read_b64_tr_b16 v[46:47], v7 offset:43520
    s_waitcnt lgkmcnt(9)
    v_mfma_f32_32x32x16_bf16 v[96:111], v[160:163], v[48:51], v[96:111]
    ds_read_b128 v[168:171], v4 offset:32768
    ds_read_b64_tr_b16 v[48:49], v6 offset:36864
    ds_read_b64_tr_b16 v[50:51], v6 offset:37376
    v_mfma_f32_32x32x16_bf16 v[112:127], v[160:163], v[52:55], v[112:127]
    ds_read_b64_tr_b16 v[52:53], v7 offset:36864
    ds_read_b64_tr_b16 v[54:55], v7 offset:37376
    s_waitcnt lgkmcnt(9)
    v_mfma_f32_32x32x16_bf16 v[64:79], v[164:167], v[32:35], v[64:79]
    ds_read_b64_tr_b16 v[32:33], v6 offset:45056
    ds_read_b64_tr_b16 v[34:35], v6 offset:45568
    v_mfma_f32_32x32x16_bf16 v[80:95], v[164:167], v[36:39], v[80:95]
    ds_read_b64_tr_b16 v[36:37], v7 offset:45056
    ds_read_b64_tr_b16 v[38:39], v7 offset:45568
    s_waitcnt lgkmcnt(9)
    v_mfma_f32_32x32x16_bf16 v[96:111], v[164:167], v[40:43], v[96:111]
    ds_read_b128 v[172:175], v5 offset:32768
    ds_read_b64_tr_b16 v[40:41], v6 offset:38912
    ds_read_b64_tr_b16 v[42:43], v6 offset:39424
    v_mfma_f32_32x32x16_bf16 v[112:127], v[164:167], v[44:47], v[112:127]
    ds_read_b64_tr_b16 v[44:45], v7 offset:38912
    ds_read_b64_tr_b16 v[46:47], v7 offset:39424
    s_waitcnt lgkmcnt(9)
    v_mfma_f32_32x32x16_bf16 v[64:79], v[168:171], v[48:51], v[64:79]
    ds_read_b64_tr_b16 v[48:49], v6 offset:47104
    ds_read_b64_tr_b16 v[50:51], v6 offset:47616
    ds_read_b32 v254, v10 offset:268
    v_mfma_f32_32x32x16_bf16 v[80:95], v[168:171], v[52:55], v[80:95]
    ds_read_b64_tr_b16 v[52:53], v7 offset:47104
    ds_read_b64_tr_b16 v[54:55], v7 offset:47616
    ds_add_u32 v13, v11 offset:0
    s_waitcnt lgkmcnt(11)
    v_mfma_f32_32x32x16_bf16 v[96:111], v[168:171], v[32:35], v[96:111]
    s_waitcnt lgkmcnt(3)
    v_cmp_eq_u32 vcc, 2, v254
    s_cbranch_vccnz L_back_141
    s_mov_b32 s3, 0
L_slow_140:
    ds_read_b32 v254, v10 offset:268
    s_add_u32 s3, s3, 1
    s_cmp_gt_u32 s3, 60000
    s_cbranch_scc1 L_abort
    s_waitcnt lgkmcnt(0)
    v_cmp_ne_u32 vcc, 2, v254
    s_cbranch_vccnz L_slow_140
L_back_141:
    ds_read_b128 v[176:179], v2 offset:49152
    ds_read_b64_tr_b16 v[32:33], v6 offset:49152
    ds_read_b64_tr_b16 v[34:35], v6 offset:49664
    v_mfma_f32_32x32x16_bf16 v[112:127], v[168:171], v[36:39], v[112:127]
    ds_read_b64_tr_b16 v[36:37], v7 offset:49152
    ds_read_b64_tr_b16 v[38:39], v7 offset:49664
    v_mfma_f32_32x32x16_bf16 v[64:79], v[172:175], v[40:43], v[64:79]
    ds_read_b64_tr_b16 v[40:41], v6 offset:57344
    ds_read_b64_tr_b16 v[42:43], v6 offset:57856
    v_mfma_f32_32x32x16_bf16 v[80:95], v[172:175], v[44:47], v[80:95]
    ds_read_b64_tr_b16 v[44:45], v7 offset:57344
    ds_read_b64_tr_b16 v[46:47], v7 offset:57856
    s_waitcnt lgkmcnt(10)
    v_mfma_f32_32x32x16_bf16 v[96:111], v[172:175], v[48:51], v[96:111]
    ds_read_b128 v[180:183], v3 offset:49152
    ds_read_b64_tr_b16 v[48:49], v6 offset:51200
    ds_read_b64_tr_b16 v[50:51], v6 offset:51712
    v_mfma_f32_32x32x16_bf16 v[112:127], v[172:175], v[52:55], v[112:127]
    ds_read_b64_tr_b16 v[52:53], v7 offset:51200
    ds_read_b64_tr_b16 v[54:55], v7 offset:51712
    s_waitcnt lgkmcnt(9)
    v_mfma_f32_32x32x16_bf16 v[64:79], v[176:179], v[32:35], v[64:79]
    ds_read_b64_tr_b16 v[32:33], v6 offset:59392
    ds_read_b64_tr_b16 v[34:35], v6 offset:59904
    v_mfma_f32_32x32x16_bf16 v[80:95], v[176:179], v[36:39], v[80:95]
    ds_read_b64_tr_b16 v[36:37], v7 offset:59392
    ds_read_b64_tr_b16 v[38:39], v7 offset:59904
    s_waitcnt lgkmcnt(9)
    v_mfma_f32_32x32x16_bf16 v[96:111], v[176:179], v[40:43], v[96:111]
    ds_read_b128 v[184:187], v4 offset:49152
    ds_read_b64_tr_b16 v[40:41], v6 offset:53248
    ds_read_b64_tr_b16 v[42:43], v6 offset:53760
    v_mfma_f32_32x32x16_bf16 v[112:127], v[176:179], v[44:47], v[112:127]
    ds_read_b64_tr_b16 v[44:45], v7 offset:53248
    ds_read_b64_tr_b16 v[46:47], v7 offset:53760
    s_waitcnt lgkmcnt(9)
    v_mfma_f32_32x32x16_bf16 v[64:79], v[180:183], v[48:51], v[64:79]
    ds_read_b64_tr_b16 v[48:49], v6 offset:61440
    ds_read_b64_tr_b16 v[50:51], v6 offset:61952
    v_mfma_f32_32x32x16_bf16 v[80:95], v[180:183], v[52:55], v[80:95]
    ds_read_b64_tr_b16 v[52:53], v7 offset:61440
    ds_read_b64_tr_b16 v[54:55], v7 offset:61952
    s_waitcnt lgkmcnt(9)
    v_mfma_f32_32x32x16_bf16 v[96:111], v[180:183], v[32:35], v[96:111]
    ds_read_b128 v[188:191], v5 offset:49152
    ds_read_b64_tr_b16 v[32:33], v6 offset:55296
    ds_read_b64_tr_b16 v[34:35], v6 offset:55808
    v_mfma_f32_32x32x16_bf16 v[112:127], v[180:183], v[36:39], v[112:127]
    ds_read_b64_tr_b16 v[36:37], v7 offset:55296
    ds_read_b64_tr_b16 v[38:39], v7 offset:55808
    s_waitcnt lgkmcnt(9)
    v_mfma_f32_32x32x16_bf16 v[64:79], v[184:187], v[40:43], v[64:79]
    ds_read_b64_tr_b16 v[40:41], v6 offset:63488
    ds_read_b64_tr_b16 v[42:43], v6 offset:64000
    ds_read_b32 v254, v10 offset:272
    v_mfma_f32_32x32x16_bf16 v[80:95], v[184:187], v[44:47], v[80:95]
    ds_read_b64_tr_b16 v[44:45], v7 offset:63488
    ds_read_b64_tr_b16 v[46:47], v7 offset:64000
    ds_add_u32 v13, v11 offset:0
    s_waitcnt lgkmcnt(11)
    v_mfma_f32_32x32x16_bf16 v[96:111], v[184:187], v[48:51], v[96:111]
    s_waitcnt lgkmcnt(3)
    v_cmp_eq_u32 vcc, 2, v254
    s_cbranch_vccnz L_back_143
    s_mov_b32 s3, 0
L_slow_142:
    ds_read_b32 v254, v10 offset:272
    s_add_u32 s3, s3, 1
    s_cmp_gt_u32 s3, 60000
    s_cbranch_scc1 L_abort
    s_waitcnt lgkmcnt(0)
    v_cmp_ne_u32 vcc, 2, v254
    s_cbranch_vccnz L_slow_142
L_back_143:
    ds_read_b128 v[192:195], v2 offset:0
    ds_read_b64_tr_b16 v[48:49], v6 offset:0
    ds_read_b64_tr_b16 v[50:51], v6 offset:512
    v_mfma_f32_32x32x16_bf16 v[112:127], v[184:187], v[52:55], v[112:127]
    ds_read_b64_tr_b16 v[52:53], v7 offset:0
    ds_read_b64_tr_b16 v[54:55], v7 offset:512
    v_mfma_f32_32x32x16_bf16 v[64:79], v[188:191], v[32:35], v[64:79]
    ds_read_b64_tr_b16 v[32:33], v6 offset:8192
    ds_read_b64_tr_b16 v[34:35], v6 offset:8704
    v_mfma_f32_32x32x16_bf16 v[80:95], v[188:191], v[36:39], v[80:95]
    ds_read_b64_tr_b16 v[36:37], v7 offset:8192
    ds_read_b64_tr_b16 v[38:39], v7 offset:8704
    s_waitcnt lgkmcnt(10)
    v_mfma_f32_32x32x16_bf16 v[96:111], v[188:191], v[40:43], v[96:111]
    ds_read_b128 v[196:199], v3 offset:0
    ds_read_b64_tr_b16 v[40:41], v6 offset:2048
    ds_read_b64_tr_b16 v[42:43], v6 offset:2560
    v_mfma_f32_32x32x16_bf16 v[112:127], v[188:191], v[44:47], v[112:127]
    ds_read_b64_tr_b16 v[44:45], v7 offset:2048
    ds_read_b64_tr_b16 v[46:47], v7 offset:2560
    s_waitcnt lgkmcnt(9)
    v_mfma_f32_32x32x16_bf16 v[64:79], v[192:195], v[48:51], v[64:79]
    ds_read_b64_tr_b16 v[48:49], v6 offset:10240
    ds_read_b64_tr_b16 v[50:51], v6 offset:10752
    v_mfma_f32_32x32x16_bf16 v[80:95], v[192:195], v[52:55], v[80:95]
    ds_read_b64_tr_b16 v[52:53], v7 offset:10240
    ds_read_b64_tr_b16 v[54:55], v7 offset:10752
    s_waitcnt lgkmcnt(9)
    v_mfma_f32_32x32x16_bf16 v[96:111], v[192:195], v[32:35], v[96:111]
    ds_read_b128 v[200:203], v4 offset:0
    ds_read_b64_tr_b16 v[32:33], v6 offset:4096
    ds_read_b64_tr_b16 v[34:35], v6 offset:4608
    v_mfma_f32_32x32x16_bf16 v[112:127], v[192:195], v[36:39], v[112:127]
    ds_read_b64_tr_b16 v[36:37], v7 offset:4096
    ds_read_b64_tr_b16 v[38:39], v7 offset:4608
    s_waitcnt lgkmcnt(9)
    v_mfma_f32_32x32x16_bf16 v[64:79], v[196:199], v[40:43], v[64:79]
    ds_read_b64_tr_b16 v[40:41], v6 offset:12288
    ds_read_b64_tr_b16 v[42:43], v6 offset:12800
    v_mfma_f32_32x32x16_bf16 v[80:95], v[196:199], v[44:47], v[80:95]
    ds_read_b64_tr_b16 v[44:45], v7 offset:12288
    ds_read_b64_tr_b16 v[46:47], v7 offset:12800
    s_waitcnt lgkmcnt(9)
    v_mfma_f32_32x32x16_bf16 v[96:111], v[196:199], v[48:51], v[96:111]
    ds_read_b128 v[204:207], v5 offset:0
    ds_read_b64_tr_b16 v[48:49], v6 offset:6144
    ds_read_b64_tr_b16 v[50:51], v6 offset:6656
    v_mfma_f32_32x32x16_bf16 v[112:127], v[196:199], v[52:55], v[112:127]
    ds_read_b64_tr_b16 v[52:53], v7 offset:6144
    ds_read_b64_tr_b16 v[54:55], v7 offset:6656
    s_waitcnt lgkmcnt(9)
    v_mfma_f32_32x32x16_bf16 v[64:79], v[200:203], v[32:35], v[64:79]
    ds_read_b64_tr_b16 v[32:33], v6 offset:14336
    ds_read_b64_tr_b16 v[34:35], v6 offset:14848
    ds_read_b32 v254, v10 offset:276
    v_mfma_f32_32x32x16_bf16 v[80:95], v[200:203], v[36:39], v[80:95]
    ds_read_b64_tr_b16 v[36:37], v7 offset:14336
    ds_read_b64_tr_b16 v[38:39], v7 offset:14848
    s_waitcnt lgkmcnt(10)
    v_mfma_f32_32x32x16_bf16 v[96:111], v[200:203], v[40:43], v[96:111]
    s_waitcnt lgkmcnt(2)
    v_cmp_eq_u32 vcc, 2, v254
    s_cbranch_vccnz L_back_145
    s_mov_b32 s3, 0
L_slow_144:
    ds_read_b32 v254, v10 offset:276
    s_add_u32 s3, s3, 1
    s_cmp_gt_u32 s3, 60000
    s_cbranch_scc1 L_abort
    s_waitcnt lgkmcnt(0)
    v_cmp_ne_u32 vcc, 2, v254
    s_cbranch_vccnz L_slow_144
L_back_145:
    s_waitcnt vmcnt(0)
    ds_read_b128 v[208:211], v2 offset:16384
    ds_read_b64_tr_b16 v[40:41], v6 offset:16384
    ds_read_b64_tr_b16 v[42:43], v6 offset:16896
    v_mfma_f32_32x32x16_bf16 v[112:127], v[200:203], v[44:47], v[112:127]
    ds_read_b64_tr_b16 v[44:45], v7 offset:16384
    ds_read_b64_tr_b16 v[46:47], v7 offset:16896
    v_mfma_f32_32x32x16_bf16 v[64:79], v[204:207], v[48:51], v[64:79]
    ds_read_b64_tr_b16 v[48:49], v6 offset:24576
    ds_read_b64_tr_b16 v[50:51], v6 offset:25088
    v_mfma_f32_32x32x16_bf16 v[80:95], v[204:207], v[52:55], v[80:95]
    ds_read_b64_tr_b16 v[52:53], v7 offset:24576
    ds_read_b64_tr_b16 v[54:55], v7 offset:25088
    s_waitcnt lgkmcnt(9)
    v_mfma_f32_32x32x16_bf16 v[96:111], v[204:207], v[32:35], v[96:111]
    ds_read_b128 v[212:215], v3 offset:16384
    ds_read_b64_tr_b16 v[32:33], v6 offset:18432
    ds_read_b64_tr_b16 v[34:35], v6 offset:18944
    v_mfma_f32_32x32x16_bf16 v[112:127], v[204:207], v[36:39], v[112:127]
    ds_read_b64_tr_b16 v[36:37], v7 offset:18432
    ds_read_b64_tr_b16 v[38:39], v7 offset:18944
    s_waitcnt lgkmcnt(9)
    v_mfma_f32_32x32x16_bf16 v[64:79], v[208:211], v[40:43], v[64:79]
    ds_read_b64_tr_b16 v[40:41], v6 offset:26624
    ds_read_b64_tr_b16 v[42:43], v6 offset:27136
    v_mfma_f32_32x32x16_bf16 v[80:95], v[208:211], v[44:47], v[80:95]
    ds_read_b64_tr_b16 v[44:45], v7 offset:26624
    ds_read_b64_tr_b16 v[46:47], v7 offset:27136
    s_waitcnt lgkmcnt(9)
    v_mfma_f32_32x32x16_bf16 v[96:111], v[208:211], v[48:51], v[96:111]
    ds_read_b128 v[216:219], v4 offset:16384
    ds_read_b64_tr_b16 v[48:49], v6 offset:20480
    ds_read_b64_tr_b16 v[50:51], v6 offset:20992
    v_mfma_f32_32x32x16_bf16 v[112:127], v[208:211], v[52:55], v[112:127]
    ds_read_b64_tr_b16 v[52:53], v7 offset:20480
    ds_read_b64_tr_b16 v[54:55], v7 offset:20992
    s_waitcnt lgkmcnt(9)
    v_mfma_f32_32x32x16_bf16 v[64:79], v[212:215], v[32:35], v[64:79]
    ds_read_b64_tr_b16 v[32:33], v6 offset:28672
    ds_read_b64_tr_b16 v[34:35], v6 offset:29184
    v_mfma_f32_32x32x16_bf16 v[80:95], v[212:215], v[36:39], v[80:95]
    ds_read_b64_tr_b16 v[36:37], v7 offset:28672
    ds_read_b64_tr_b16 v[38:39], v7 offset:29184
    s_waitcnt lgkmcnt(9)
    v_mfma_f32_32x32x16_bf16 v[96:111], v[212:215], v[40:43], v[96:111]
    ds_read_b128 v[220:223], v5 offset:16384
    ds_read_b64_tr_b16 v[40:41], v6 offset:22528
    ds_read_b64_tr_b16 v[42:43], v6 offset:23040
    v_mfma_f32_32x32x16_bf16 v[112:127], v[212:215], v[44:47], v[112:127]
    ds_read_b64_tr_b16 v[44:45], v7 offset:22528
    ds_read_b64_tr_b16 v[46:47], v7 offset:23040
    s_waitcnt lgkmcnt(9)
    v_mfma_f32_32x32x16_bf16 v[64:79], v[216:219], v[48:51], v[64:79]
    ds_read_b64_tr_b16 v[48:49], v6 offset:30720
    ds_read_b64_tr_b16 v[50:51], v6 offset:31232
    ds_read_b32 v254, v10 offset:280
    v_mfma_f32_32x32x16_bf16 v[80:95], v[216:219], v[52:55], v[80:95]
    ds_read_b64_tr_b16 v[52:53], v7 offset:30720
    ds_read_b64_tr_b16 v[54:55], v7 offset:31232
    s_waitcnt lgkmcnt(10)
    v_mfma_f32_32x32x16_bf16 v[96:111], v[216:219], v[32:35], v[96:111]
    s_waitcnt lgkmcnt(2)
    v_cmp_eq_u32 vcc, 2, v254
    s_cbranch_vccnz L_back_147
    s_mov_b32 s3, 0
L_slow_146:
    ds_read_b32 v254, v10 offset:280
    s_add_u32 s3, s3, 1
    s_cmp_gt_u32 s3, 60000
    s_cbranch_scc1 L_abort
    s_waitcnt lgkmcnt(0)
    v_cmp_ne_u32 vcc, 2, v254
    s_cbranch_vccnz L_slow_146
L_back_147:
    ds_read_b128 v[224:227], v2 offset:32768
    ds_read_b64_tr_b16 v[32:33], v6 offset:32768
    ds_read_b64_tr_b16 v[34:35], v6 offset:33280
    v_mfma_f32_32x32x16_bf16 v[112:127], v[216:219], v[36:39], v[112:127]
    ds_read_b64_tr_b16 v[36:37], v7 offset:32768
    ds_read_b64_tr_b16 v[38:39], v7 offset:33280
    v_mfma_f32_32x32x16_bf16 v[64:79], v[220:223], v[40:43], v[64:79]
    ds_read_b64_tr_b16 v[40:41], v6 offset:40960
    ds_read_b64_tr_b16 v[42:43], v6 offset:41472
    v_mfma_f32_32x32x16_bf16 v[80:95], v[220:223], v[44:47], v[80:95]
    ds_read_b64_tr_b16 v[44:45], v7 offset:40960
    ds_read_b64_tr_b16 v[46:47], v7 offset:41472
    s_waitcnt lgkmcnt(9)
    v_mfma_f32_32x32x16_bf16 v[96:111], v[220:223], v[48:51], v[96:111]
    ds_read_b128 v[228:231], v3 offset:32768
    ds_read_b64_tr_b16 v[48:49], v6 offset:34816
    ds_read_b64_tr_b16 v[50:51], v6 offset:35328
    v_mfma_f32_32x32x16_bf16 v[112:127], v[220:223], v[52:55], v[112:127]
    ds_read_b64_tr_b16 v[52:53], v7 offset:34816
    ds_read_b64_tr_b16 v[54:55], v7 offset:35328
    s_waitcnt lgkmcnt(9)
    v_mfma_f32_32x32x16_bf16 v[64:79], v[224:227], v[32:35], v[64:79]
    ds_read_b64_tr_b16 v[32:33], v6 offset:43008
    ds_read_b64_tr_b16 v[34:35], v6 offset:43520
    v_mfma_f32_32x32x16_bf16 v[80:95], v[224:227], v[36:39], v[80:95]
    ds_read_b64_tr_b16 v[36:37], v7 offset:43008
    ds_read_b64_tr_b16 v[38:39], v7 offset:43520
    s_waitcnt lgkmcnt(9)
    v_mfma_f32_32x32x16_bf16 v[96:111], v[224:227], v[40:43], v[96:111]
    ds_read_b128 v[232:235], v4 offset:32768
    ds_read_b64_tr_b16 v[40:41], v6 offset:36864
    ds_read_b64_tr_b16 v[42:43], v6 offset:37376
    v_mfma_f32_32x32x16_bf16 v[112:127], v[224:227], v[44:47], v[112:127]
    ds_read_b64_tr_b16 v[44:45], v7 offset:36864
    ds_read_b64_tr_b16 v[46:47], v7 offset:37376
    s_waitcnt lgkmcnt(9)
    v_mfma_f32_32x32x16_bf16 v[64:79], v[228:231], v[48:51], v[64:79]
    ds_read_b64_tr_b16 v[48:49], v6 offset:45056
    ds_read_b64_tr_b16 v[50:51], v6 offset:45568
    v_mfma_f32_32x32x16_bf16 v[80:95], v[228:231], v[52:55], v[80:95]
    ds_read_b64_tr_b16 v[52:53], v7 offset:45056
    ds_read_b64_tr_b16 v[54:55], v7 offset:45568
    s_waitcnt lgkmcnt(9)
    v_mfma_f32_32x32x16_bf16 v[96:111], v[228:231], v[32:35], v[96:111]
    ds_read_b128 v[236:239], v5 offset:32768
    ds_read_b64_tr_b16 v[32:33], v6 offset:47104
    ds_read_b64_tr_b16 v[34:35], v6 offset:47616
    v_mfma_f32_32x32x16_bf16 v[112:127], v[228:231], v[36:39], v[112:127]
    ds_read_b64_tr_b16 v[36:37], v7 offset:47104
    ds_read_b64_tr_b16 v[38:39], v7 offset:47616
    s_waitcnt lgkmcnt(9)
    v_mfma_f32_32x32x16_bf16 v[64:79], v[232:235], v[40:43], v[64:79]
    ds_read_b64_tr_b16 v[40:41], v6 offset:38912
    ds_read_b64_tr_b16 v[42:43], v6 offset:39424
    v_mfma_f32_32x32x16_bf16 v[80:95], v[232:235], v[44:47], v[80:95]
    ds_read_b64_tr_b16 v[44:45], v7 offset:38912
    ds_read_b64_tr_b16 v[46:47], v7 offset:39424
    ds_add_u32 v13, v11 offset:32
    s_waitcnt lgkmcnt(10)
    v_mfma_f32_32x32x16_bf16 v[96:111], v[232:235], v[48:51], v[96:111]
    v_mfma_f32_32x32x16_bf16 v[112:127], v[232:235], v[52:55], v[112:127]
    s_waitcnt lgkmcnt(5)
    v_mfma_f32_32x32x16_bf16 v[96:111], v[236:239], v[32:35], v[96:111]
    v_mfma_f32_32x32x16_bf16 v[112:127], v[236:239], v[36:39], v[112:127]
    s_waitcnt lgkmcnt(1)
    v_mfma_f32_32x32x16_bf16 v[64:79], v[236:239], v[40:43], v[64:79]
    v_mfma_f32_32x32x16_bf16 v[80:95], v[236:239], v[44:47], v[80:95]
    s_nop 7
    v_cvt_pk_bf16_f32 v16, v96, v97
    v_cvt_pk_bf16_f32 v17, v98, v99
    v_cvt_pk_bf16_f32 v18, v100, v101
    v_cvt_pk_bf16_f32 v19, v102, v103
    v_cvt_pk_bf16_f32 v20, v104, v105
    v_cvt_pk_bf16_f32 v21, v106, v107
    v_cvt_pk_bf16_f32 v22, v108, v109
    v_cvt_pk_bf16_f32 v23, v110, v111
    v_cvt_pk_bf16_f32 v24, v112, v113
    v_cvt_pk_bf16_f32 v25, v114, v115
    v_cvt_pk_bf16_f32 v26, v116, v117
    v_cvt_pk_bf16_f32 v27, v118, v119
    v_cvt_pk_bf16_f32 v28, v120, v121
    v_cvt_pk_bf16_f32 v29, v122, v123
    v_cvt_pk_bf16_f32 v30, v124, v125
    v_cvt_pk_bf16_f32 v31, v126, v127
    ds_write_b128 v15, v[16:19] offset:16384
    ds_write_b128 v15, v[20:23] offset:17408
    ds_write_b128 v15, v[24:27] offset:18432
    ds_write_b128 v15, v[28:31] offset:19456
    ds_add_u32 v13, v11 offset:80
    v_mul_f32 v250, s72, v64
    v_mul_f32_e64 v251, s72, v65
    v_exp_f32_e64 v250, v250 clamp
    v_exp_f32_e64 v251, v251 clamp
    v_max_f32 v64, 0, v64
    v_max_f32 v65, 0, v65
    v_add_f32 v64, v64, v250
    v_add_f32 v65, v65, v251
    v_cvt_pk_bf16_f32 v64, v64, v65
    v_mul_f32 v250, s72, v66
    v_mul_f32 v251, s72, v67
    v_exp_f32_e64 v250, v250 clamp
    v_exp_f32_e64 v251, v251 clamp
    v_max_f32 v66, 0, v66
    v_max_f32 v67, 0, v67
    v_add_f32 v66, v66, v250
    v_add_f32 v67, v67, v251
    v_cvt_pk_bf16_f32 v65, v66, v67
    v_mul_f32 v250, s72, v68
    v_mul_f32 v251, s72, v69
    v_exp_f32_e64 v250, v250 clamp
    v_exp_f32_e64 v251, v251 clamp
    v_max_f32 v68, 0, v68
    v_max_f32 v69, 0, v69
    v_add_f32 v68, v68, v250
    v_add_f32 v69, v69, v251
    v_cvt_pk_bf16_f32 v66, v68, v69
    v_mul_f32 v250, s72, v70
    v_mul_f32 v251, s72, v71
    v_exp_f32_e64 v250, v250 clamp
    v_exp_f32_e64 v251, v251 clamp
    v_max_f32 v70, 0, v70
    v_max_f32 v71, 0, v71
    v_add_f32 v70, v70, v250
    v_add_f32 v71, v71, v251
    v_cvt_pk_bf16_f32 v67, v70, v71
    ds_write_b128 v15, v[64:67] offset:32768
    v_mul_f32 v250, s72, v72
    v_mul_f32 v251, s72, v73
    v_exp_f32_e64 v250, v250 clamp
    v_exp_f32_e64 v251, v251 clamp
    v_max_f32 v72, 0, v72
    v_max_f32 v73, 0, v73
    v_add_f32 v72, v72, v250
    v_add_f32 v73, v73, v251
    v_cvt_pk_bf16_f32 v68, v72, v73
    v_mul_f32 v250, s72, v74
    v_mul_f32 v251, s72, v75
    v_exp_f32_e64 v250, v250 clamp
    v_exp_f32_e64 v251, v251 clamp
    v_max_f32 v74, 0, v74
    v_max_f32 v75, 0, v75
    v_add_f32 v74, v74, v250
    v_add_f32 v75, v75, v251
    v_cvt_pk_bf16_f32 v69, v74, v75
    v_mul_f32 v250, s72, v76
    v_mul_f32 v251, s72, v77
    v_exp_f32_e64 v250, v250 clamp
    v_exp_f32_e64 v251, v251 clamp
    v_max_f32 v76, 0, v76
    v_max_f32 v77, 0, v77
    v_add_f32 v76, v76, v250
    v_add_f32 v77, v77, v251
    v_cvt_pk_bf16_f32 v70, v76, v77
    v_mul_f32 v250, s72, v78
    v_mul_f32 v251, s72, v79
    v_exp_f32_e64 v250, v250 clamp
    v_exp_f32_e64 v251, v251 clamp
    v_max_f32 v78, 0, v78
    v_max_f32 v79, 0, v79
    v_add_f32 v78, v78, v250
    v_add_f32 v79, v79, v251
    v_cvt_pk_bf16_f32 v71, v78, v79
    ds_write_b128 v15, v[68:71] offset:33792
    v_mul_f32 v250, s72, v80
    v_mul_f32 v251, s72, v81
    v_exp_f32_e64 v250, v250 clamp
    v_exp_f32_e64 v251, v251 clamp
    v_max_f32 v80, 0, v80
    v_max_f32 v81, 0, v81
    v_add_f32 v80, v80, v250
    v_add_f32 v81, v81, v251
    v_cvt_pk_bf16_f32 v80, v80, v81
    v_mul_f32 v250, s72, v82
    v_mul_f32 v251, s72, v83
    v_exp_f32_e64 v250, v250 clamp
    v_exp_f32_e64 v251, v251 clamp
    v_max_f32 v82, 0, v82
    v_max_f32 v83, 0, v83
    v_add_f32 v82, v82, v250
    v_add_f32 v83, v83, v251
    v_cvt_pk_bf16_f32 v81, v82, v83
    v_mul_f32 v250, s72, v84
    v_mul_f32 v251, s72, v85
    v_exp_f32_e64 v250, v250 clamp
    v_exp_f32_e64 v251, v251 clamp
    v_max_f32 v84, 0, v84
    v_max_f32 v85, 0, v85
    v_add_f32 v84, v84, v250
    v_add_f32 v85, v85, v251
    v_cvt_pk_bf16_f32 v82, v84, v85
    v_mul_f32 v250, s72, v86
    v_mul_f32 v251, s72, v87
    v_exp_f32_e64 v250, v250 clamp
    v_exp_f32_e64 v251, v251 clamp
    v_max_f32 v86, 0, v86
    v_max_f32 v87, 0, v87
    v_add_f32 v86, v86, v250
    v_add_f32 v87, v87, v251
    v_cvt_pk_bf16_f32 v83, v86, v87
    ds_write_b128 v15, v[80:83] offset:34816
    v_mul_f32 v250, s72, v88
    v_mul_f32 v251, s72, v89
    v_exp_f32_e64 v250, v250 clamp
    v_exp_f32_e64 v251, v251 clamp
    v_max_f32 v88, 0, v88
    v_max_f32 v89, 0, v89
    v_add_f32 v88, v88, v250
    v_add_f32 v89, v89, v251
    v_cvt_pk_bf16_f32 v84, v88, v89
    v_mul_f32 v250, s72, v90
    v_mul_f32 v251, s72, v91
    v_exp_f32_e64 v250, v250 clamp
    v_exp_f32_e64 v251, v251 clamp
    v_max_f32 v90, 0, v90
    v_max_f32 v91, 0, v91
    v_add_f32 v90, v90, v250
    v_add_f32 v91, v91, v251
    v_cvt_pk_bf16_f32 v85, v90, v91
    v_mul_f32 v250, s72, v92
    v_mul_f32 v251, s72, v93
    v_exp_f32_e64 v250, v250 clamp
    v_exp_f32_e64 v251, v251 clamp
    v_max_f32 v92, 0, v92
    v_max_f32 v93, 0, v93
    v_add_f32 v92, v92, v250
    v_add_f32 v93, v93, v251
    v_cvt_pk_bf16_f32 v86, v92, v93
    v_mul_f32 v250, s72, v94
    v_mul_f32 v251, s72, v95
    v_exp_f32_e64 v250, v250 clamp
    v_exp_f32_e64 v251, v251 clamp
    v_max_f32 v94, 0, v94
    v_max_f32 v95, 0, v95
    v_add_f32 v94, v94, v250
    v_add_f32 v95, v95, v251
    v_cvt_pk_bf16_f32 v87, v94, v95
    ds_write_b128 v15, v[84:87] offset:35840
    ds_add_u32 v13, v11 offset:64
    s_waitcnt lgkmcnt(0)
    s_mov_b32 s3, 0
L_wl_160:
    ds_read_b32 v252, v10 offset:284
    s_add_u32 s3, s3, 1
    s_cmp_gt_u32 s3, 60000
    s_cbranch_scc1 L_abort
    s_waitcnt lgkmcnt(0)
    v_cmp_ne_u32 vcc, 2, v252
    s_cbranch_vccnz L_wl_160
    ds_read_b64_tr_b16 v[48:49], v8 offset:16384
    ds_read_b64_tr_b16 v[50:51], v8 offset:16640
    ds_read_b64_tr_b16 v[52:53], v8 offset:17408
    ds_read_b64_tr_b16 v[54:55], v8 offset:17664
    ds_read_b64_tr_b16 v[32:33], v8 offset:18432
    ds_read_b64_tr_b16 v[34:35], v8 offset:18688
    ds_read_b32 v254, v10 offset:292
    s_waitcnt lgkmcnt(3)
    v_mfma_f32_32x32x16_bf16 v[96:111], v[48:51], v[128:131], 0
    ds_read_b64_tr_b16 v[36:37], v8 offset:19456
    ds_read_b64_tr_b16 v[38:39], v8 offset:19712
    s_waitcnt lgkmcnt(2)
    v_cmp_ne_u32 vcc, 2, v254
    s_cbranch_vccnz L_slow_162
L_back_163:
    ds_read_b64_tr_b16 v[40:41], v8 offset:20480
    ds_read_b64_tr_b16 v[42:43], v8 offset:20736
    ds_read_b64_tr_b16 v[44:45], v8 offset:21504
    ds_read_b64_tr_b16 v[46:47], v8 offset:21760
    ds_read_b64_tr_b16 v[48:49], v8 offset:22528
    ds_read_b64_tr_b16 v[50:51], v8 offset:22784
    v_mfma_f32_32x32x16_bf16 v[96:111], v[52:55], v[132:135], v[96:111]
    ds_read_b64_tr_b16 v[52:53], v8 offset:23552
    ds_read_b64_tr_b16 v[54:55], v8 offset:23808
    s_waitcnt lgkmcnt(8)
    v_mfma_f32_32x32x16_bf16 v[96:111], v[32:35], v[136:139], v[96:111]
    ds_read_b64_tr_b16 v[32:33], v8 offset:24576
    ds_read_b64_tr_b16 v[34:35], v8 offset:24832
    v_mfma_f32_32x32x16_bf16 v[96:111], v[36:39], v[140:143], v[96:111]
    ds_read_b64_tr_b16 v[36:37], v8 offset:25600
    ds_read_b64_tr_b16 v[38:39], v8 offset:25856
    s_waitcnt lgkmcnt(8)
    v_mfma_f32_32x32x16_bf16 v[96:111], v[40:43], v[144:147], v[96:111]
    ds_read_b64_tr_b16 v[40:41], v8 offset:26624
    ds_read_b64_tr_b16 v[42:43], v8 offset:26880
    ds_read_b32 v254, v10 offset:300
    v_mfma_f32_32x32x16_bf16 v[96:111], v[44:47], v[148:151], v[96:111]
    ds_read_b64_tr_b16 v[44:45], v8 offset:27648
    ds_read_b64_tr_b16 v[46:47], v8 offset:27904
    s_waitcnt lgkmcnt(9)
    v_mfma_f32_32x32x16_bf16 v[96:111], v[48:51], v[152:155], v[96:111]
    s_waitcnt lgkmcnt(2)
    v_cmp_ne_u32 vcc, 2, v254
    s_cbranch_vccnz L_slow_164
L_back_165:
    ds_read_b64_tr_b16 v[48:49], v8 offset:28672
    ds_read_b64_tr_b16 v[50:51], v8 offset:28928
    v_mfma_f32_32x32x16_bf16 v[96:111], v[52:55], v[156:159], v[96:111]
    ds_read_b64_tr_b16 v[52:53], v8 offset:29696
    ds_read_b64_tr_b16 v[54:55], v8 offset:29952
    v_mfma_f32_32x32x16_bf16 v[96:111], v[32:35], v[160:163], v[96:111]
    ds_read_b64_tr_b16 v[32:33], v8 offset:30720
    ds_read_b64_tr_b16 v[34:35], v8 offset:30976
    v_mfma_f32_32x32x16_bf16 v[96:111], v[36:39], v[164:167], v[96:111]
    ds_read_b64_tr_b16 v[36:37], v8 offset:31744
    ds_read_b64_tr_b16 v[38:39], v8 offset:32000
    s_waitcnt lgkmcnt(8)
    v_mfma_f32_32x32x16_bf16 v[96:111], v[40:43], v[168:171], v[96:111]
    ds_read_b64_tr_b16 v[40:41], v8 offset:32768
    ds_read_b64_tr_b16 v[42:43], v8 offset:33024
    v_mfma_f32_32x32x16_bf16 v[96:111], v[44:47], v[172:175], v[96:111]
    ds_read_b64_tr_b16 v[44:45], v8 offset:33792
    ds_read_b64_tr_b16 v[46:47], v8 offset:34048
    s_waitcnt lgkmcnt(8)
    v_mfma_f32_32x32x16_bf16 v[96:111], v[48:51], v[176:179], v[96:111]
    ds_read_b64_tr_b16 v[48:49], v8 offset:34816
    ds_read_b64_tr_b16 v[50:51], v8 offset:35072
    ds_read_b32 v254, v10 offset:308
    v_mfma_f32_32x32x16_bf16 v[96:111], v[52:55], v[180:183], v[96:111]
    ds_read_b64_tr_b16 v[52:53], v8 offset:35840
    ds_read_b64_tr_b16 v[54:55], v8 offset:36096
    s_waitcnt lgkmcnt(9)
    v_mfma_f32_32x32x16_bf16 v[96:111], v[32:35], v[184:187], v[96:111]
    s_waitcnt lgkmcnt(2)
    v_cmp_ne_u32 vcc, 2, v254
    s_cbranch_vccnz L_slow_166
L_back_167:
    ds_read_b64_tr_b16 v[32:33], v8 offset:36864
    ds_read_b64_tr_b16 v[34:35], v8 offset:37120
    v_mfma_f32_32x32x16_bf16 v[96:111], v[36:39], v[188:191], v[96:111]
    ds_read_b64_tr_b16 v[36:37], v8 offset:37888
    ds_read_b64_tr_b16 v[38:39], v8 offset:38144
    v_mfma_f32_32x32x16_bf16 v[96:111], v[40:43], v[192:195], v[96:111]
    ds_read_b64_tr_b16 v[40:41], v8 offset:38912
    ds_read_b64_tr_b16 v[42:43], v8 offset:39168
    v_mfma_f32_32x32x16_bf16 v[96:111], v[44:47], v[196:199], v[96:111]
    ds_read_b64_tr_b16 v[44:45], v8 offset:39936
    ds_read_b64_tr_b16 v[46:47], v8 offset:40192
    s_waitcnt lgkmcnt(8)
    v_mfma_f32_32x32x16_bf16 v[96:111], v[48:51], v[200:203], v[96:111]
    ds_read_b64_tr_b16 v[48:49], v8 offset:0
    ds_read_b64_tr_b16 v[50:51], v8 offset:256
    v_mfma_f32_32x32x16_bf16 v[96:111], v[52:55], v[204:207], v[96:111]
    ds_read_b64_tr_b16 v[52:53], v8 offset:1024
    ds_read_b64_tr_b16 v[54:55], v8 offset:1280
    s_waitcnt lgkmcnt(8)
    v_mfma_f32_32x32x16_bf16 v[96:111], v[32:35], v[208:211], v[96:111]
    ds_read_b64_tr_b16 v[32:33], v8 offset:2048
    ds_read_b64_tr_b16 v[34:35], v8 offset:2304
    ds_read_b32 v254, v10 offset:312
    v_mfma_f32_32x32x16_bf16 v[96:111], v[36:39], v[212:215], v[96:111]
    ds_read_b64_tr_b16 v[36:37], v8 offset:3072
    ds_read_b64_tr_b16 v[38:39], v8 offset:3328
    ds_add_u32 v13, v11 offset:144
    s_waitcnt lgkmcnt(10)
    v_mfma_f32_32x32x16_bf16 v[96:111], v[40:43], v[216:219], v[96:111]
    s_waitcnt lgkmcnt(3)
    v_cmp_ne_u32 vcc, 2, v254
    s_cbranch_vccnz L_slow_168
L_back_169:
    ds_read_b64_tr_b16 v[40:41], v9 offset:4096
    ds_read_b64_tr_b16 v[42:43], v9 offset:4352
    v_mfma_f32_32x32x16_bf16 v[96:111], v[44:47], v[220:223], v[96:111]
    ds_read_b64_tr_b16 v[44:45], v9 offset:5120
    ds_read_b64_tr_b16 v[46:47], v9 offset:5376
    v_mfma_f32_32x32x16_bf16 v[96:111], v[48:51], v[224:227], v[96:111]
    ds_read_b64_tr_b16 v[48:49], v9 offset:6144
    ds_read_b64_tr_b16 v[50:51], v9 offset:6400
    ds_read_b32 v254, v10 offset:320
    v_mfma_f32_32x32x16_bf16 v[96:111], v[52:55], v[228:231], v[96:111]
    ds_read_b64_tr_b16 v[52:53], v9 offset:7168
    ds_read_b64_tr_b16 v[54:55], v9 offset:7424
    s_waitcnt lgkmcnt(10)
    v_mfma_f32_32x32x16_bf16 v[96:111], v[32:35], v[232:235], v[96:111]
    s_waitcnt lgkmcnt(2)
    v_cmp_ne_u32 vcc, 2, v254
    s_cbranch_vccnz L_slow_170
L_back_171:
    ds_read_b64_tr_b16 v[32:33], v9 offset:8192
    ds_read_b64_tr_b16 v[34:35], v9 offset:8448
    v_mfma_f32_32x32x16_bf16 v[96:111], v[36:39], v[236:239], v[96:111]
    ds_read_b64_tr_b16 v[36:37], v9 offset:9216
    ds_read_b64_tr_b16 v[38:39], v9 offset:9472
    v_mfma_f32_32x32x16_bf16 v[112:127], v[40:43], v[128:131], 0
    ds_read_b64_tr_b16 v[40:41], v9 offset:10240
    ds_read_b64_tr_b16 v[42:43], v9 offset:10496
    v_mfma_f32_32x32x16_bf16 v[112:127], v[44:47], v[132:135], v[112:127]
    ds_read_b64_tr_b16 v[44:45], v9 offset:11264
    ds_read_b64_tr_b16 v[46:47], v9 offset:11520
    s_waitcnt lgkmcnt(8)
    v_mfma_f32_32x32x16_bf16 v[112:127], v[48:51], v[136:139], v[112:127]
    ds_read_b64_tr_b16 v[48:49], v9 offset:12288
    ds_read_b64_tr_b16 v[50:51], v9 offset:12544
    v_mfma_f32_32x32x16_bf16 v[112:127], v[52:55], v[140:143], v[112:127]
    ds_read_b64_tr_b16 v[52:53], v9 offset:13312
    ds_read_b64_tr_b16 v[54:55], v9 offset:13568
    s_waitcnt lgkmcnt(8)
    v_mfma_f32_32x32x16_bf16 v[112:127], v[32:35], v[144:147], v[112:127]
    v_cvt_pk_bf16_f32 v16, v96, v97
    v_cvt_pk_bf16_f32 v17, v98, v99
    ds_read_b64_tr_b16 v[32:33], v9 offset:14336
    ds_read_b64_tr_b16 v[34:35], v9 offset:14592
    ds_read_b32 v254, v10 offset:328
    v_mfma_f32_32x32x16_bf16 v[112:127], v[36:39], v[148:151], v[112:127]
    v_cvt_pk_bf16_f32 v18, v100, v101
    v_cvt_pk_bf16_f32 v19, v102, v103
    ds_read_b64_tr_b16 v[36:37], v9 offset:15360
    ds_read_b64_tr_b16 v[38:39], v9 offset:15616
    s_waitcnt lgkmcnt(9)
    v_mfma_f32_32x32x16_bf16 v[112:127], v[40:43], v[152:155], v[112:127]
    v_cvt_pk_bf16_f32 v20, v104, v105
    v_cvt_pk_bf16_f32 v21, v106, v107
    s_waitcnt lgkmcnt(2)
    v_cmp_ne_u32 vcc, 2, v254
    s_cbranch_vccnz L_slow_172
L_back_173:
    v_subrev_u32 v9, 65536, v9
    ds_read_b64_tr_b16 v[40:41], v9 offset:0
    ds_read_b64_tr_b16 v[42:43], v9 offset:256
    v_mfma_f32_32x32x16_bf16 v[112:127], v[44:47], v[156:159], v[112:127]
    v_cvt_pk_bf16_f32 v22, v108, v109
    v_cvt_pk_bf16_f32 v23, v110, v111
    ds_read_b64_tr_b16 v[44:45], v9 offset:1024
    ds_read_b64_tr_b16 v[46:47], v9 offset:1280
    v_mfma_f32_32x32x16_bf16 v[112:127], v[48:51], v[160:163], v[112:127]
    ds_write_b128 v15, v[16:19] offset:0
    ds_write_b128 v15, v[20:23] offset:1024
    ds_read_b64_tr_b16 v[48:49], v9 offset:2048
    ds_read_b64_tr_b16 v[50:51], v9 offset:2304
    v_mfma_f32_32x32x16_bf16 v[112:127], v[52:55], v[164:167], v[112:127]
    ds_add_u32 v13, v11 offset:96
    ds_read_b64_tr_b16 v[52:53], v9 offset:3072
    ds_read_b64_tr_b16 v[54:55], v9 offset:3328
    s_waitcnt lgkmcnt(11)
    v_mfma_f32_32x32x16_bf16 v[112:127], v[32:35], v[168:171], v[112:127]
    ds_read_b64_tr_b16 v[32:33], v9 offset:4096
    ds_read_b64_tr_b16 v[34:35], v9 offset:4352
    v_mfma_f32_32x32x16_bf16 v[112:127], v[36:39], v[172:175], v[112:127]
    ds_read_b64_tr_b16 v[36:37], v9 offset:5120
    ds_read_b64_tr_b16 v[38:39], v9 offset:5376
    s_waitcnt lgkmcnt(11)
    v_mfma_f32_32x32x16_bf16 v[112:127], v[40:43], v[176:179], v[112:127]
    ds_read_b64_tr_b16 v[40:41], v9 offset:6144
    ds_read_b64_tr_b16 v[42:43], v9 offset:6400
    ds_read_b32 v254, v10 offset:336
    v_mfma_f32_32x32x16_bf16 v[112:127], v[44:47], v[180:183], v[112:127]
    ds_read_b64_tr_b16 v[44:45], v9 offset:7168
    ds_read_b64_tr_b16 v[46:47], v9 offset:7424
    s_waitcnt lgkmcnt(9)
    v_mfma_f32_32x32x16_bf16 v[112:127], v[48:51], v[184:187], v[112:127]
    s_waitcnt lgkmcnt(2)
    v_cmp_ne_u32 vcc, 2, v254
    s_cbranch_vccnz L_slow_174
L_back_175:
    ds_read_b64_tr_b16 v[48:49], v9 offset:8192
    ds_read_b64_tr_b16 v[50:51], v9 offset:8448
    v_mfma_f32_32x32x16_bf16 v[112:127], v[52:55], v[188:191], v[112:127]
    ds_read_b64_tr_b16 v[52:53], v9 offset:9216
    ds_read_b64_tr_b16 v[54:55], v9 offset:9472
    v_mfma_f32_32x32x16_bf16 v[112:127], v[32:35], v[192:195], v[112:127]
    ds_read_b64_tr_b16 v[32:33], v9 offset:10240
    ds_read_b64_tr_b16 v[34:35], v9 offset:10496
    v_mfma_f32_32x32x16_bf16 v[112:127], v[36:39], v[196:199], v[112:127]
    ds_read_b64_tr_b16 v[36:37], v9 offset:11264
    ds_read_b64_tr_b16 v[38:39], v9 offset:11520
    s_waitcnt lgkmcnt(8)
    v_mfma_f32_32x32x16_bf16 v[112:127], v[40:43], v[200:203], v[112:127]
    ds_read_b64_tr_b16 v[40:41], v9 offset:12288
    ds_read_b64_tr_b16 v[42:43], v9 offset:12544
    v_mfma_f32_32x32x16_bf16 v[112:127], v[44:47], v[204:207], v[112:127]
    ds_read_b64_tr_b16 v[44:45], v9 offset:13312
    ds_read_b64_tr_b16 v[46:47], v9 offset:13568
    s_waitcnt lgkmcnt(8)
    v_mfma_f32_32x32x16_bf16 v[112:127], v[48:51], v[208:211], v[112:127]
    ds_read_b64_tr_b16 v[48:49], v9 offset:14336
    ds_read_b64_tr_b16 v[50:51], v9 offset:14592
    v_mfma_f32_32x32x16_bf16 v[112:127], v[52:55], v[212:215], v[112:127]
    ds_read_b64_tr_b16 v[52:53], v9 offset:15360
    ds_read_b64_tr_b16 v[54:55], v9 offset:15616
    ds_add_u32 v13, v11 offset:48
    s_waitcnt lgkmcnt(9)
    v_mfma_f32_32x32x16_bf16 v[112:127], v[32:35], v[216:219], v[112:127]
    v_mfma_f32_32x32x16_bf16 v[112:127], v[36:39], v[220:223], v[112:127]
    s_waitcnt lgkmcnt(5)
    v_mfma_f32_32x32x16_bf16 v[112:127], v[40:43], v[224:227], v[112:127]
    v_mfma_f32_32x32x16_bf16 v[112:127], v[44:47], v[228:231], v[112:127]
    s_waitcnt lgkmcnt(1)
    v_mfma_f32_32x32x16_bf16 v[112:127], v[48:51], v[232:235], v[112:127]
    v_mfma_f32_32x32x16_bf16 v[112:127], v[52:55], v[236:239], v[112:127]
    s_nop 11
    v_cvt_pk_bf16_f32 v240, v112, v113
    v_cvt_pk_bf16_f32 v241, v114, v115
    v_cvt_pk_bf16_f32 v242, v116, v117
    v_cvt_pk_bf16_f32 v243, v118, v119
    v_cvt_pk_bf16_f32 v244, v120, v121
    v_cvt_pk_bf16_f32 v245, v122, v123
    v_cvt_pk_bf16_f32 v246, v124, v125
    v_cvt_pk_bf16_f32 v247, v126, v127
    v_and_b32 v240, v240, v248
    v_and_b32 v241, v241, v248
    v_and_b32 v246, v246, v249
    v_and_b32_e64 v247, v247, v249
L_attn:
    s_setprio 3
    s_lshl_b32 s29, s24, 11
    s_add_u32 s30, s29, 16384
    v_add_u32_e64 v2, s30, v1
    s_add_u32 s30, s29, 131072
    v_add_u32 v3, s30, v1
    s_lshl_b32 s29, s24, 8
    s_add_u32 s29, s29, 160256
    v_lshl_add_u32 v8, v0, 2, s29
    s_lshl_b32 s29, s24, 2
    s_add_u32 s29, s29, 158720
    v_mov_b32_e64 v9, s29
    s_lshl_b32 s29, s75, 4
    s_add_u32 s29, s29, s25
    s_lshr_b32 s30, s29, 3
    s_lshl_b32 s30, s30, 5
    s_and_b32 s31, s25, 7
    s_add_u32 s30, s30, s31
    s_lshl_b32 s30, s30, 2
    s_add_u32 s38, s30, 11141120
    s_lshl_b32 s29, s29, 11
    s_add_u32 s37, s29, 4194304
    s_min_u32 s36, s75, 8
    s_sub_u32 s36, 8, s36
    s_and_b32 s29, s26, 3
    s_lshl_b32 s29, s29, 3
    s_and_b32 s30, s25, 7
    s_add_u32 s100, s29, s30
    s_cmp_ge_u32 s100, 14
    s_cselect_b32 s29, 14, 0
    s_cselect_b32 s30, 1, 0
    s_sub_u32 s29, s100, s29
    s_lshr_b32 s10, s29, 1
    s_and_b32 s29, s29, 1
    s_lshr_b32 s31, s25, 3
    s_lshl_b32 s31, s31, 1
    s_add_u32 s30, s30, s31
    s_and_b32 s31, s26, 12
    s_add_u32 s30, s30, s31
    s_lshl_b32 s30, s30, 1
    s_add_u32 s30, s30, s29
    s_lshl_b32 s11, s30, 1
    s_lshr_b32 s75, s101, 1
    s_and_b32 s12, s101, 1
    s_add_u32 s13, s11, s12
    v_bfe_u32 v131, v0, 2, 2
    v_bfe_u32 v128, v0, 4, 1
    v_and_b32_e64 v132, 3, v0
    v_lshl_add_u32 v132, v128, 2, v132
    v_lshlrev_b32_e64 v132, 3, v132
    s_mul_i32 s29, s75, 67584
    s_add_u32 s29, s29, 40960
    v_add_u32 v132, s29, v132
    v_lshrrev_b32 v130, 5, v0
    v_mul_u32_u24 v130, 7, v130
    v_min_u32 v128, 3, v131
    v_add3_u32 v128, v128, v130, 0
    v_bfe_u32 v129, v128, 1, 1
    v_xor_b32_e64 v129, s75, v129
    v_lshl_add_u32 v7, v128, 7, v132
    v_lshl_add_u32 v7, v129, 6, v7
    v_min_u32_e64 v128, 2, v131
    v_add3_u32 v128, v128, v130, 4
    v_bfe_u32 v129, v128, 1, 1
    v_xor_b32_e64 v129, s75, v129
    v_lshl_add_u32 v12, v128, 7, v132
    v_lshl_add_u32 v12, v129, 6, v12
    v_min_u32_e64 v128, 3, v131
    v_add3_u32 v128, v128, v130, 14
    v_bfe_u32 v129, v128, 1, 1
    v_xor_b32_e64 v129, s75, v129
    v_lshl_add_u32 v14, v128, 7, v132
    v_lshl_add_u32 v14, v129, 6, v14
    v_min_u32_e64 v128, 2, v131
    v_add3_u32 v128, v128, v130, 18
    v_bfe_u32 v129, v128, 1, 1
    v_xor_b32_e64 v129, s75, v129
    v_lshl_add_u32 v248, v128, 7, v132
    v_lshl_add_u32 v248, v129, 6, v248
    s_lshl_b32 s29, s13, 1
    s_add_u32 s29, s29, s75
    s_lshl_b32 s14, s29, 7
    s_lshl_b32 s29, s29, 14
    v_add_u32_e64 v249, s29, v1
    s_waitcnt lgkmcnt(0)
    s_mov_b32 s3, 0
L_wl_178:
    ds_read_b32 v252, v10 offset:340
    s_add_u32 s3, s3, 1
    s_cmp_gt_u32 s3, 60000
    s_cbranch_scc1 L_abort
    s_waitcnt lgkmcnt(0)
    v_cmp_ne_u32 vcc, 2, v252
    s_cbranch_vccnz L_wl_178
    ds_read_b128 v[128:131], v2 offset:0
    ds_read_b128 v[132:135], v2 offset:1024
    ds_read_b128 v[192:195], v2 offset:16384
    ds_read_b128 v[196:199], v2 offset:17408
    ds_read_b128 v[136:139], v2 offset:2048
    ds_read_b128 v[140:143], v2 offset:3072
    ds_read_b128 v[144:147], v2 offset:4096
    ds_read_b128 v[148:151], v2 offset:5120
    s_waitcnt lgkmcnt(6)
    v_mfma_f32_32x32x16_bf16 v[96:111], v[128:131], v[240:243], 0
    v_mfma_f32_32x32x16_bf16 v[96:111], v[132:135], v[244:247], v[96:111]
    s_waitcnt lgkmcnt(4)
    v_mfma_f32_32x32x16_bf16 v[80:95], v[192:195], v[240:243], 0
    v_mfma_f32_32x32x16_bf16 v[80:95], v[196:199], v[244:247], v[80:95]
    ds_read_b128 v[152:155], v2 offset:6144
    ds_read_b128 v[156:159], v2 offset:7168
    ds_read_b128 v[160:163], v2 offset:8192
    ds_read_b128 v[164:167], v2 offset:9216
    ds_read_b128 v[168:171], v2 offset:10240
    ds_read_b128 v[172:175], v2 offset:11264
    ds_read_b128 v[176:179], v2 offset:12288
    ds_read_b128 v[180:183], v2 offset:13312
    ds_read_b128 v[184:187], v2 offset:14336
    ds_read_b128 v[188:191], v2 offset:15360
    ds_add_u32 v13, v11 offset:144
    s_cmp_lg_u32 s36, 0
    s_cbranch_scc1 L_nf_180
L_nfb_181:
    v_cndmask_b32 v80, v96, v80, s[40:41]
    v_cndmask_b32 v81, v97, v81, s[42:43]
    v_cndmask_b32 v82, v98, v82, s[44:45]
    v_cndmask_b32 v83, v99, v83, s[46:47]
    v_cndmask_b32 v84, v100, v84, s[48:49]
    v_cndmask_b32 v85, v101, v85, s[50:51]
    v_cndmask_b32 v86, v102, v86, s[52:53]
    v_cndmask_b32 v87, v103, v87, s[54:55]
    v_cndmask_b32 v88, v104, v88, s[56:57]
    v_cndmask_b32 v89, v105, v89, s[58:59]
    v_cndmask_b32 v90, v106, v90, s[60:61]
    v_cndmask_b32 v91, v107, v91, s[62:63]
    v_cndmask_b32 v92, v108, v92, s[64:65]
    v_cndmask_b32 v93, v109, v93, s[66:67]
    v_cndmask_b32 v94, v110, v94, s[68:69]
    v_cndmask_b32 v95, v111, v95, s[70:71]
    v_max3_f32 v4, v80, v81, v82
    v_max3_f32 v4, v4, v83, v84
    v_max3_f32 v4, v4, v85, v86
    v_max3_f32 v4, v4, v87, v88
    v_max3_f32 v4, v4, v89, v90
    v_max3_f32 v4, v4, v91, v92
    v_max3_f32 v4, v4, v93, v94
    v_max_f32 v4, v4, v95
    v_mov_b32 v250, v4
    s_nop 1
    v_permlane32_swap_b32 v250, v4
    v_max_f32 v4, v4, v250
    v_sub_f32 v4, 0, v4
    v_mov_b32 v16, v4
    v_mov_b32 v17, v4
    v_mov_b32 v18, v4
    v_mov_b32 v19, v4
    v_mov_b32 v20, v4
    v_mov_b32 v21, v4
    v_mov_b32 v22, v4
    v_mov_b32 v23, v4
    v_mov_b32 v24, v4
    v_mov_b32 v25, v4
    v_mov_b32 v26, v4
    v_mov_b32 v27, v4
    v_mov_b32 v28, v4
    v_mov_b32 v29, v4
    v_mov_b32 v30, v4
    v_mov_b32 v31, v4
    s_cmp_gt_u32 s36, 1
    s_cbranch_scc1 L_nc_182
L_ncb_183:
    s_waitcnt lgkmcnt(14)
    v_mfma_f32_32x32x16_bf16 v[64:79], v[136:139], v[240:243], v[16:31]
    v_add_f32 v80, v80, v4
    v_add_f32 v81, v81, v4
    v_add_f32 v82, v82, v4
    v_add_f32 v83, v83, v4
    v_add_f32 v84, v84, v4
    v_add_f32 v85, v85, v4
    v_add_f32 v86, v86, v4
    v_add_f32 v87, v87, v4
    v_add_f32 v88, v88, v4
    v_add_f32 v89, v89, v4
    v_add_f32 v90, v90, v4
    v_add_f32 v91, v91, v4
    v_add_f32 v92, v92, v4
    v_add_f32 v93, v93, v4
    v_add_f32 v94, v94, v4
    v_add_f32 v95, v95, v4
    v_exp_f32 v80, v80
    v_exp_f32 v81, v81
    v_exp_f32 v82, v82
    v_exp_f32_e64 v83, v83
    s_waitcnt lgkmcnt(13)
    v_mfma_f32_32x32x16_bf16 v[64:79], v[140:143], v[244:247], v[64:79]
    ds_read_b32 v252, v10 offset:344
    v_cvt_pk_bf16_f32 v200, v80, v81
    v_exp_f32 v84, v84
    v_exp_f32 v85, v85
    v_cvt_pk_bf16_f32 v201, v82, v83
    v_exp_f32 v86, v86
    v_exp_f32 v87, v87
    v_cvt_pk_bf16_f32 v202, v84, v85
    v_exp_f32 v88, v88
    v_exp_f32 v89, v89
    v_cvt_pk_bf16_f32 v203, v86, v87
    v_exp_f32 v90, v90
    v_exp_f32 v91, v91
    v_cvt_pk_bf16_f32 v204, v88, v89
    v_exp_f32 v92, v92
    v_exp_f32 v93, v93
    v_cvt_pk_bf16_f32 v205, v90, v91
    v_exp_f32 v94, v94
    v_exp_f32 v95, v95
    v_cvt_pk_bf16_f32 v206, v92, v93
    v_cvt_pk_bf16_f32 v207, v94, v95
    s_waitcnt lgkmcnt(0)
    v_cmp_ne_u32 vcc, 2, v252
    s_cbranch_vccnz L_slow_176
L_back_177:
    ds_read_b128 v[224:227], v3 offset:0
    ds_read_b128 v[228:231], v3 offset:1024
    ds_read_b128 v[232:235], v3 offset:16384
    ds_read_b128 v[236:239], v3 offset:17408
    v_and_b32 v208, v200, v56
    v_xor_b32 v216, v200, v208
    v_and_b32 v209, v201, v57
    v_xor_b32 v217, v201, v209
    v_and_b32 v210, v202, v58
    v_xor_b32 v218, v202, v210
    v_and_b32 v211, v203, v59
    v_xor_b32 v219, v203, v211
    v_and_b32 v212, v204, v60
    v_xor_b32 v220, v204, v212
    v_and_b32 v213, v205, v61
    v_xor_b32 v221, v205, v213
    v_and_b32 v214, v206, v62
    v_xor_b32 v222, v206, v214
    v_and_b32 v215, v207, v63
    v_xor_b32_e64 v223, v207, v215
    s_cmp_eq_u32 s36, 2
    s_cbranch_scc1 L_g_186
L_gb_187:
    v_mfma_f32_32x32x16_bf16 v[32:47], v[144:147], v[240:243], v[16:31]
    v_exp_f32 v64, v64
    v_exp_f32 v65, v65
    v_exp_f32 v66, v66
    v_exp_f32 v67, v67
    v_mfma_f32_32x32x16_bf16 v[32:47], v[148:151], v[244:247], v[32:47]
    v_cvt_pk_bf16_f32 v200, v64, v65
    v_exp_f32 v68, v68
    v_exp_f32 v69, v69
    v_cvt_pk_bf16_f32 v201, v66, v67
    s_waitcnt lgkmcnt(0)
    v_mfma_f32_32x32x16_bf16 v[96:111], v[224:227], v[216:219], 0
    v_exp_f32 v70, v70
    v_exp_f32_e64 v71, v71
    v_cvt_pk_bf16_f32 v202, v68, v69
    v_exp_f32_e64 v72, v72
    v_mfma_f32_32x32x16_bf16 v[96:111], v[228:231], v[220:223], v[96:111]
    ds_read_b128 v[224:227], v3 offset:2048
    ds_read_b128 v[228:231], v3 offset:3072
    v_exp_f32_e64 v73, v73
    v_cvt_pk_bf16_f32 v203, v70, v71
    v_exp_f32 v74, v74
    v_exp_f32 v75, v75
    v_mfma_f32_32x32x16_bf16 v[96:111], v[232:235], v[208:211], v[96:111]
    v_cvt_pk_bf16_f32 v204, v72, v73
    v_exp_f32 v76, v76
    v_exp_f32 v77, v77
    v_cvt_pk_bf16_f32 v205, v74, v75
    v_mfma_f32_32x32x16_bf16 v[96:111], v[236:239], v[212:215], v[96:111]
    ds_read_b128 v[232:235], v3 offset:4096
    ds_read_b128 v[236:239], v3 offset:5120
    v_exp_f32 v78, v78
    v_exp_f32 v79, v79
    v_cvt_pk_bf16_f32 v206, v76, v77
    v_cvt_pk_bf16_f32 v207, v78, v79
    s_cmp_eq_u32 s36, 3
    s_cbranch_scc1 L_g_188
L_gb_189:
    v_mfma_f32_32x32x16_bf16 v[64:79], v[152:155], v[240:243], v[16:31]
    v_exp_f32 v32, v32
    v_exp_f32 v33, v33
    v_exp_f32 v34, v34
    v_exp_f32 v35, v35
    v_cvt_pk_bf16_f32 v208, v32, v33
    v_exp_f32_e64 v36, v36
    v_mfma_f32_32x32x16_bf16 v[64:79], v[156:159], v[244:247], v[64:79]
    v_exp_f32_e64 v37, v37
    v_cvt_pk_bf16_f32 v209, v34, v35
    v_exp_f32 v38, v38
    v_exp_f32 v39, v39
    v_cvt_pk_bf16_f32 v210, v36, v37
    v_exp_f32 v40, v40
    s_waitcnt lgkmcnt(2)
    v_mfma_f32_32x32x16_bf16 v[96:111], v[224:227], v[200:203], v[96:111]
    v_exp_f32_e64 v41, v41
    v_cvt_pk_bf16_f32 v211, v38, v39
    v_exp_f32 v42, v42
    v_exp_f32 v43, v43
    v_cvt_pk_bf16_f32 v212, v40, v41
    v_exp_f32_e64 v44, v44
    v_mfma_f32_32x32x16_bf16 v[96:111], v[228:231], v[204:207], v[96:111]
    ds_read_b128 v[224:227], v3 offset:6144
    ds_read_b128 v[228:231], v3 offset:7168
    v_exp_f32_e64 v45, v45
    v_cvt_pk_bf16_f32 v213, v42, v43
    v_exp_f32 v46, v46
    v_exp_f32 v47, v47
    v_cvt_pk_bf16_f32 v214, v44, v45
    v_cvt_pk_bf16_f32 v215, v46, v47
    s_cmp_eq_u32 s36, 4
    s_cbranch_scc1 L_g_190
L_gb_191:
    v_mfma_f32_32x32x16_bf16 v[32:47], v[160:163], v[240:243], v[16:31]
    v_exp_f32 v64, v64
    v_exp_f32 v65, v65
    v_exp_f32 v66, v66
    v_exp_f32 v67, v67
    v_cvt_pk_bf16_f32 v200, v64, v65
    v_exp_f32_e64 v68, v68
    v_mfma_f32_32x32x16_bf16 v[32:47], v[164:167], v[244:247], v[32:47]
    v_exp_f32_e64 v69, v69
    v_cvt_pk_bf16_f32 v201, v66, v67
    v_exp_f32 v70, v70
    v_exp_f32 v71, v71
    v_cvt_pk_bf16_f32 v202, v68, v69
    v_exp_f32 v72, v72
    s_waitcnt lgkmcnt(2)
    v_mfma_f32_32x32x16_bf16 v[96:111], v[232:235], v[208:211], v[96:111]
    v_exp_f32_e64 v73, v73
    v_cvt_pk_bf16_f32 v203, v70, v71
    v_exp_f32 v74, v74
    v_exp_f32 v75, v75
    v_cvt_pk_bf16_f32 v204, v72, v73
    v_exp_f32_e64 v76, v76
    v_mfma_f32_32x32x16_bf16 v[96:111], v[236:239], v[212:215], v[96:111]
    ds_read_b128 v[232:235], v3 offset:8192
    ds_read_b128 v[236:239], v3 offset:9216
    v_exp_f32_e64 v77, v77
    v_cvt_pk_bf16_f32 v205, v74, v75
    v_exp_f32 v78, v78
    v_exp_f32 v79, v79
    v_cvt_pk_bf16_f32 v206, v76, v77
    v_cvt_pk_bf16_f32 v207, v78, v79
    s_cmp_eq_u32 s36, 5
    s_cbranch_scc1 L_g_192
L_gb_193:
    v_mfma_f32_32x32x16_bf16 v[64:79], v[168:171], v[240:243], v[16:31]
    v_exp_f32 v32, v32
    v_exp_f32 v33, v33
    v_exp_f32 v34, v34
    v_exp_f32 v35, v35
    v_cvt_pk_bf16_f32 v208, v32, v33
    v_exp_f32_e64 v36, v36
    v_mfma_f32_32x32x16_bf16 v[64:79], v[172:175], v[244:247], v[64:79]
    v_exp_f32_e64 v37, v37
    v_cvt_pk_bf16_f32 v209, v34, v35
    v_exp_f32 v38, v38
    v_exp_f32 v39, v39
    v_cvt_pk_bf16_f32 v210, v36, v37
    v_exp_f32 v40, v40
    s_waitcnt lgkmcnt(2)
    v_mfma_f32_32x32x16_bf16 v[96:111], v[224:227], v[200:203], v[96:111]
    v_exp_f32_e64 v41, v41
    v_cvt_pk_bf16_f32 v211, v38, v39
    v_exp_f32 v42, v42
    v_exp_f32 v43, v43
    v_cvt_pk_bf16_f32 v212, v40, v41
    v_exp_f32_e64 v44, v44
    v_mfma_f32_32x32x16_bf16 v[96:111], v[228:231], v[204:207], v[96:111]
    ds_read_b128 v[224:227], v3 offset:10240
    ds_read_b128 v[228:231], v3 offset:11264
    v_exp_f32_e64 v45, v45
    v_cvt_pk_bf16_f32 v213, v42, v43
    v_exp_f32 v46, v46
    v_exp_f32 v47, v47
    v_cvt_pk_bf16_f32 v214, v44, v45
    v_cvt_pk_bf16_f32 v215, v46, v47
    s_cmp_eq_u32 s36, 6
    s_cbranch_scc1 L_g_194
L_gb_195:
    v_mfma_f32_32x32x16_bf16 v[32:47], v[176:179], v[240:243], v[16:31]
    v_exp_f32 v64, v64
    v_exp_f32 v65, v65
    v_exp_f32 v66, v66
    v_exp_f32 v67, v67
    v_cvt_pk_bf16_f32 v200, v64, v65
    v_exp_f32_e64 v68, v68
    v_mfma_f32_32x32x16_bf16 v[32:47], v[180:183], v[244:247], v[32:47]
    v_exp_f32_e64 v69, v69
    v_cvt_pk_bf16_f32 v201, v66, v67
    v_exp_f32 v70, v70
    v_exp_f32 v71, v71
    v_cvt_pk_bf16_f32 v202, v68, v69
    v_exp_f32 v72, v72
    s_waitcnt lgkmcnt(2)
    v_mfma_f32_32x32x16_bf16 v[96:111], v[232:235], v[208:211], v[96:111]
    v_exp_f32_e64 v73, v73
    v_cvt_pk_bf16_f32 v203, v70, v71
    v_exp_f32 v74, v74
    v_exp_f32 v75, v75
    v_cvt_pk_bf16_f32 v204, v72, v73
    v_exp_f32_e64 v76, v76
    v_mfma_f32_32x32x16_bf16 v[96:111], v[236:239], v[212:215], v[96:111]
    ds_read_b128 v[232:235], v3 offset:12288
    ds_read_b128 v[236:239], v3 offset:13312
    v_exp_f32_e64 v77, v77
    v_cvt_pk_bf16_f32 v205, v74, v75
    v_exp_f32 v78, v78
    v_exp_f32 v79, v79
    v_cvt_pk_bf16_f32 v206, v76, v77
    v_cvt_pk_bf16_f32 v207, v78, v79
    s_cmp_eq_u32 s36, 7
    s_cbranch_scc1 L_g_196
L_gb_197:
    v_mfma_f32_32x32x16_bf16 v[64:79], v[184:187], v[240:243], v[16:31]
    v_exp_f32 v32, v32
    v_exp_f32 v33, v33
    v_exp_f32 v34, v34
    v_exp_f32 v35, v35
    v_cvt_pk_bf16_f32 v208, v32, v33
    v_exp_f32_e64 v36, v36
    v_mfma_f32_32x32x16_bf16 v[64:79], v[188:191], v[244:247], v[64:79]
    v_exp_f32_e64 v37, v37
    v_cvt_pk_bf16_f32 v209, v34, v35
    v_exp_f32 v38, v38
    v_exp_f32 v39, v39
    v_cvt_pk_bf16_f32 v210, v36, v37
    v_exp_f32 v40, v40
    s_waitcnt lgkmcnt(2)
    v_mfma_f32_32x32x16_bf16 v[96:111], v[224:227], v[200:203], v[96:111]
    v_exp_f32_e64 v41, v41
    v_cvt_pk_bf16_f32 v211, v38, v39
    v_exp_f32 v42, v42
    v_exp_f32 v43, v43
    v_cvt_pk_bf16_f32 v212, v40, v41
    v_exp_f32_e64 v44, v44
    v_mfma_f32_32x32x16_bf16 v[96:111], v[228:231], v[204:207], v[96:111]
    ds_read_b128 v[224:227], v3 offset:14336
    ds_read_b128 v[228:231], v3 offset:15360
    ds_read_b32 v5, v9 offset:176
    v_exp_f32_e64 v45, v45
    v_cvt_pk_bf16_f32 v213, v42, v43
    v_exp_f32 v46, v46
    v_exp_f32 v47, v47
    v_cvt_pk_bf16_f32 v214, v44, v45
    v_cvt_pk_bf16_f32 v215, v46, v47
    s_waitcnt lgkmcnt(0)
    v_cmp_gt_u32 vcc, 1, v5
    s_cbranch_vccnz L_slow_184
L_back_185:
    ds_read_b32 v5, v8
    ds_read_b32 v6, v10 offset:208
    v_mfma_f32_32x32x16_bf16 v[96:111], v[232:235], v[208:211], v[96:111]
    v_exp_f32 v64, v64
    v_exp_f32 v65, v65
    v_exp_f32 v66, v66
    v_exp_f32_e64 v67, v67
    v_cvt_pk_bf16_f32 v200, v64, v65
    v_exp_f32 v68, v68
    v_exp_f32 v69, v69
    v_cvt_pk_bf16_f32 v201, v66, v67
    v_exp_f32 v70, v70
    v_exp_f32 v71, v71
    v_cvt_pk_bf16_f32 v202, v68, v69
    v_exp_f32_e64 v72, v72
    v_mfma_f32_32x32x16_bf16 v[96:111], v[236:239], v[212:215], v[96:111]
    v_exp_f32_e64 v73, v73
    v_cvt_pk_bf16_f32 v203, v70, v71
    v_exp_f32 v74, v74
    v_exp_f32 v75, v75
    v_cvt_pk_bf16_f32 v204, v72, v73
    v_exp_f32 v76, v76
    v_exp_f32 v77, v77
    v_cvt_pk_bf16_f32 v205, v74, v75
    v_exp_f32 v78, v78
    v_exp_f32 v79, v79
    v_cvt_pk_bf16_f32 v206, v76, v77
    v_cvt_pk_bf16_f32 v207, v78, v79
    v_mfma_f32_32x32x16_bf16 v[96:111], v[224:227], v[200:203], v[96:111]
    s_nop 0
    v_mfma_f32_32x32x16_bf16 v[96:111], v[228:231], v[204:207], v[96:111]
L_ctail:
    s_nop 11
    v_mov_b32 v250, v111
    v_mov_b32 v251, v111
    s_nop 1
    v_permlane32_swap_b32 v250, v251
    v_cmp_nge_f32 vcc, 0x5d800000, v251
    s_cbranch_vccnz L_attn_fb
L_ctail2:
    v_rcp_f32 v251, v251
    v_mov_b32 v250, 0xffff
    s_waitcnt lgkmcnt(1)
    v_mul_f32 v251, v251, v5
    v_mul_f32 v96, v96, v251
    v_mul_f32 v97, v97, v251
    v_cvt_pk_bf16_f32 v200, v96, v97
    v_mul_f32 v98, v98, v251
    v_mul_f32 v99, v99, v251
    v_cvt_pk_bf16_f32 v201, v98, v99
    v_mul_f32 v100, v100, v251
    v_mul_f32 v101, v101, v251
    v_cvt_pk_bf16_f32 v202, v100, v101
    v_mul_f32_e64 v102, v102, v251
    v_cvt_pk_bf16_f32 v203, v102, v103
    s_waitcnt lgkmcnt(0)
    v_bfi_b32 v203, v250, v203, v6
    buffer_store_dwordx4 v[200:203], v1, s[32:35], s37 offen offset:0 sc1
    v_mul_f32 v104, v104, v251
    v_mul_f32_e64 v105, v105, v251
    v_cvt_pk_bf16_f32 v204, v104, v105
    v_mul_f32 v106, v106, v251
    v_mul_f32 v107, v107, v251
    v_cvt_pk_bf16_f32 v205, v106, v107
    v_mul_f32 v108, v108, v251
    v_mul_f32 v109, v109, v251
    v_cvt_pk_bf16_f32 v206, v108, v109
    v_mul_f32_e64 v110, v110, v251
    v_cvt_pk_bf16_f32 v207, v110, v111
    v_bfi_b32 v207, v250, v207, v6
    buffer_store_dwordx4 v[204:207], v1, s[32:35], s37 offen offset:1024 sc1
    v_lshlrev_b32 v250, 7, v0
    s_mov_b64 exec, 1
    buffer_store_dword v6, v250, s[32:35], s38 offen sc1
    s_mov_b64 exec, -1
    ds_add_u32 v13, v11 offset:112
    s_cmp_ge_u32 s100, 28
    s_cbranch_scc1 L_cend
    v_readfirstlane_b32 s2, v6
    v_mov_b32_e64 v15, v6
    s_add_u32 s59, s14, 11141120
    s_mov_b32 s58, 4194304
    v_mov_b32 v2, v7
    v_mov_b32 v3, v12
    v_mov_b32 v4, v14
    v_mov_b32 v5, v248
    v_mov_b32_e64 v6, v249
    v_and_b32 v9, 0xffff0000, v15
    s_mul_i32 s70, s75, 60416
    s_add_u32 s70, s70, 40960
    s_mov_b32 s65, s13
    s_waitcnt lgkmcnt(0)
    s_mov_b32 s3, 0
L_wl_198:
    ds_read_b32 v28, v10 offset:352
    s_add_u32 s3, s3, 1
    s_cmp_gt_u32 s3, 60000
    s_cbranch_scc1 L_abort
    s_waitcnt lgkmcnt(0)
    v_cmp_ne_u32 vcc, 3, v28
    s_cbranch_vccnz L_wl_198
    ds_read_b64_tr_b16 v[128:129], v2 offset:0
    ds_read_b64_tr_b16 v[130:131], v3 offset:0
    ds_read_b64_tr_b16 v[132:133], v4 offset:0
    ds_read_b64_tr_b16 v[134:135], v5 offset:0
    ds_read_b64_tr_b16 v[136:137], v2 offset:3584
    ds_read_b64_tr_b16 v[138:139], v3 offset:3584
    ds_read_b64_tr_b16 v[140:141], v4 offset:3584
    ds_read_b64_tr_b16 v[142:143], v5 offset:3584
    ds_read_b64_tr_b16 v[144:145], v2 offset:7168
    ds_read_b64_tr_b16 v[146:147], v3 offset:7168
    ds_read_b64_tr_b16 v[148:149], v4 offset:7168
    ds_read_b64_tr_b16 v[150:151], v5 offset:7168
    ds_read_b64_tr_b16 v[152:153], v2 offset:10752
    ds_read_b64_tr_b16 v[154:155], v3 offset:10752
    ds_read_b64_tr_b16 v[156:157], v4 offset:10752
    ds_read_b64_tr_b16 v[158:159], v5 offset:10752
    ds_read_b64_tr_b16 v[160:161], v2 offset:14336
    ds_read_b64_tr_b16 v[162:163], v3 offset:14336
    ds_read_b64_tr_b16 v[164:165], v4 offset:14336
    ds_read_b64_tr_b16 v[166:167], v5 offset:14336
    ds_read_b64_tr_b16 v[168:169], v2 offset:17920
    ds_read_b64_tr_b16 v[170:171], v3 offset:17920
    ds_read_b64_tr_b16 v[172:173], v4 offset:17920
    ds_read_b64_tr_b16 v[174:175], v5 offset:17920
    v_subrev_u32 v2, s70, v2
    v_subrev_u32 v3, s70, v3
    v_subrev_u32 v4, s70, v4
    v_subrev_u32 v5, s70, v5
    ds_read_b64_tr_b16 v[176:177], v2 offset:0
    ds_read_b64_tr_b16 v[178:179], v3 offset:0
    ds_read_b64_tr_b16 v[180:181], v4 offset:0
    ds_read_b64_tr_b16 v[182:183], v5 offset:0
    ds_read_b64_tr_b16 v[184:185], v2 offset:3584
    ds_read_b64_tr_b16 v[186:187], v3 offset:3584
    ds_read_b64_tr_b16 v[188:189], v4 offset:3584
    ds_read_b64_tr_b16 v[190:191], v5 offset:3584
    v_xor_b32 v2, 64, v2
    v_xor_b32 v3, 64, v3
    v_xor_b32 v4, 64, v4
    v_xor_b32 v5, 64, v5
    ds_read_b64_tr_b16 v[240:241], v2 offset:0
    ds_read_b64_tr_b16 v[242:243], v3 offset:0
    ds_read_b64_tr_b16 v[244:245], v4 offset:0
    ds_read_b64_tr_b16 v[246:247], v5 offset:0
    ds_read_b64_tr_b16 v[248:249], v2 offset:3584
    ds_read_b64_tr_b16 v[250:251], v3 offset:3584
    ds_read_b64_tr_b16 v[252:253], v4 offset:3584
    ds_read_b64_tr_b16 v[254:255], v5 offset:3584
    v_add_u32 v2, s70, v2
    v_add_u32 v3, s70, v3
    v_add_u32 v4, s70, v4
    v_add_u32 v5, s70, v5
    ds_read_b64_tr_b16 v[192:193], v2 offset:0
    ds_read_b64_tr_b16 v[194:195], v3 offset:0
    ds_read_b64_tr_b16 v[196:197], v4 offset:0
    ds_read_b64_tr_b16 v[198:199], v5 offset:0
    ds_read_b64_tr_b16 v[200:201], v2 offset:3584
    ds_read_b64_tr_b16 v[202:203], v3 offset:3584
    ds_read_b64_tr_b16 v[204:205], v4 offset:3584
    ds_read_b64_tr_b16 v[206:207], v5 offset:3584
    ds_read_b64_tr_b16 v[208:209], v2 offset:7168
    ds_read_b64_tr_b16 v[210:211], v3 offset:7168
    ds_read_b64_tr_b16 v[212:213], v4 offset:7168
    ds_read_b64_tr_b16 v[214:215], v5 offset:7168
    ds_read_b64_tr_b16 v[216:217], v2 offset:10752
    ds_read_b64_tr_b16 v[218:219], v3 offset:10752
    ds_read_b64_tr_b16 v[220:221], v4 offset:10752
    ds_read_b64_tr_b16 v[222:223], v5 offset:10752
    ds_read_b64_tr_b16 v[224:225], v2 offset:14336
    ds_read_b64_tr_b16 v[226:227], v3 offset:14336
    ds_read_b64_tr_b16 v[228:229], v4 offset:14336
    ds_read_b64_tr_b16 v[230:231], v5 offset:14336
    ds_read_b64_tr_b16 v[232:233], v2 offset:17920
    ds_read_b64_tr_b16 v[234:235], v3 offset:17920
    ds_read_b64_tr_b16 v[236:237], v4 offset:17920
    ds_read_b64_tr_b16 v[238:239], v5 offset:17920
    ds_add_u32 v13, v11 offset:112
    s_waitcnt lgkmcnt(0)
    s_branch L_sub_half
L_cend:
    s_endpgm
L_attn_fb:
    v_mov_b32 v16, 0xf149f2ca
    v_mov_b32 v17, 0xf149f2ca
    v_mov_b32 v18, 0xf149f2ca
    v_mov_b32 v19, 0xf149f2ca
    v_mov_b32 v20, 0xf149f2ca
    v_mov_b32 v21, 0xf149f2ca
    v_mov_b32 v22, 0xf149f2ca
    v_mov_b32 v23, 0xf149f2ca
    v_mov_b32 v24, 0xf149f2ca
    v_mov_b32 v25, 0xf149f2ca
    v_mov_b32 v26, 0xf149f2ca
    v_mov_b32 v27, 0xf149f2ca
    v_mov_b32 v28, 0xf149f2ca
    v_mov_b32 v29, 0xf149f2ca
    v_mov_b32 v30, 0xf149f2ca
    v_mov_b32 v31, 0xf149f2ca
    s_cmp_eq_u32 s36, 0
    s_cbranch_scc1 L_g_202
L_gb_203:
    v_mfma_f32_32x32x16_bf16 v[96:111], v[128:131], v[240:243], v[16:31]
    v_mfma_f32_32x32x16_bf16 v[96:111], v[132:135], v[244:247], v[96:111]
    s_cmp_eq_u32 s36, 1
    s_cbranch_scc1 L_g_204
L_gb_205:
    v_mfma_f32_32x32x16_bf16 v[64:79], v[136:139], v[240:243], v[16:31]
    v_mfma_f32_32x32x16_bf16 v[64:79], v[140:143], v[244:247], v[64:79]
    s_cmp_eq_u32 s36, 2
    s_cbranch_scc1 L_g_206
L_gb_207:
    v_mfma_f32_32x32x16_bf16 v[112:127], v[144:147], v[240:243], v[16:31]
    v_mfma_f32_32x32x16_bf16 v[112:127], v[148:151], v[244:247], v[112:127]
    s_nop 7
    v_max3_f32 v4, v64, v65, v66
    v_max3_f32 v4, v4, v67, v68
    v_max3_f32 v4, v4, v69, v70
    v_max3_f32 v4, v4, v71, v72
    s_cmp_eq_u32 s36, 3
    s_cbranch_scc1 L_g_208
L_gb_209:
    v_mfma_f32_32x32x16_bf16 v[32:47], v[152:155], v[240:243], v[16:31]
    v_max3_f32 v4, v4, v73, v74
    v_max3_f32 v4, v4, v75, v76
    v_max3_f32 v4, v4, v77, v78
    v_max_f32_e64 v4, v4, v79
    v_mfma_f32_32x32x16_bf16 v[32:47], v[156:159], v[244:247], v[32:47]
    v_max3_f32 v4, v4, v112, v113
    v_max3_f32 v4, v4, v114, v115
    v_max3_f32 v4, v4, v116, v117
    v_max3_f32 v4, v4, v118, v119
    s_cmp_eq_u32 s36, 4
    s_cbranch_scc1 L_g_210
L_gb_211:
    v_mfma_f32_32x32x16_bf16 v[64:79], v[160:163], v[240:243], v[16:31]
    v_max3_f32 v4, v4, v120, v121
    v_max3_f32 v4, v4, v122, v123
    v_max3_f32 v4, v4, v124, v125
    v_max3_f32 v4, v4, v126, v127
    v_mfma_f32_32x32x16_bf16 v[64:79], v[164:167], v[244:247], v[64:79]
    v_max3_f32 v4, v4, v32, v33
    v_max3_f32 v4, v4, v34, v35
    v_max3_f32 v4, v4, v36, v37
    v_max3_f32 v4, v4, v38, v39
    s_cmp_eq_u32 s36, 5
    s_cbranch_scc1 L_g_212
L_gb_213:
    v_mfma_f32_32x32x16_bf16 v[112:127], v[168:171], v[240:243], v[16:31]
    v_max3_f32 v4, v4, v40, v41
    v_max3_f32 v4, v4, v42, v43
    v_max3_f32 v4, v4, v44, v45
    v_max3_f32 v4, v4, v46, v47
    v_mfma_f32_32x32x16_bf16 v[112:127], v[172:175], v[244:247], v[112:127]
    v_max3_f32 v4, v4, v64, v65
    v_max3_f32 v4, v4, v66, v67
    v_max3_f32 v4, v4, v68, v69
    v_max3_f32 v4, v4, v70, v71
    s_cmp_eq_u32 s36, 6
    s_cbranch_scc1 L_g_214
L_gb_215:
    v_mfma_f32_32x32x16_bf16 v[32:47], v[176:179], v[240:243], v[16:31]
    v_max3_f32 v4, v4, v72, v73
    v_max3_f32 v4, v4, v74, v75
    v_max3_f32 v4, v4, v76, v77
    v_max3_f32 v4, v4, v78, v79
    v_mfma_f32_32x32x16_bf16 v[32:47], v[180:183], v[244:247], v[32:47]
    v_max3_f32 v4, v4, v112, v113
    v_max3_f32 v4, v4, v114, v115
    v_max3_f32 v4, v4, v116, v117
    v_max3_f32 v4, v4, v118, v119
    s_cmp_eq_u32 s36, 7
    s_cbranch_scc1 L_g_216
L_gb_217:
    v_mfma_f32_32x32x16_bf16 v[64:79], v[184:187], v[240:243], v[16:31]
    v_max3_f32 v4, v4, v120, v121
    v_max3_f32 v4, v4, v122, v123
    v_max3_f32 v4, v4, v124, v125
    v_max3_f32 v4, v4, v126, v127
    v_mfma_f32_32x32x16_bf16 v[64:79], v[188:191], v[244:247], v[64:79]
    v_max3_f32 v4, v4, v32, v33
    v_max3_f32 v4, v4, v34, v35
    v_max3_f32 v4, v4, v36, v37
    v_max3_f32 v4, v4, v38, v39
    s_cmp_eq_u32 s36, 8
    s_cbranch_scc1 L_g_218
L_gb_219:
    v_mfma_f32_32x32x16_bf16 v[80:95], v[192:195], v[240:243], v[16:31]
    v_max3_f32 v4, v4, v40, v41
    v_max3_f32 v4, v4, v42, v43
    v_max3_f32 v4, v4, v44, v45
    v_max3_f32 v4, v4, v46, v47
    v_mfma_f32_32x32x16_bf16 v[80:95], v[196:199], v[244:247], v[80:95]
    v_max3_f32 v4, v4, v64, v65
    v_max3_f32 v4, v4, v66, v67
    v_max3_f32 v4, v4, v68, v69
    v_max3_f32 v4, v4, v70, v71
    ds_read_b32 v252, v10 offset:344
    v_max3_f32 v4, v4, v72, v73
    v_max3_f32 v4, v4, v74, v75
    v_max3_f32 v4, v4, v76, v77
    v_max3_f32 v4, v4, v78, v79
    s_nop 2
    v_cndmask_b32 v80, v96, v80, s[40:41]
    v_cndmask_b32 v81, v97, v81, s[42:43]
    v_cndmask_b32 v82, v98, v82, s[44:45]
    v_cndmask_b32 v83, v99, v83, s[46:47]
    s_waitcnt lgkmcnt(0)
    v_cmp_ne_u32 vcc, 2, v252
    s_cbranch_vccnz L_slow_200
L_back_201:
    ds_read_b128 v[224:227], v3 offset:0
    ds_read_b128 v[228:231], v3 offset:1024
    ds_read_b128 v[232:235], v3 offset:16384
    ds_read_b128 v[236:239], v3 offset:17408
    v_cndmask_b32 v84, v100, v84, s[48:49]
    v_cndmask_b32 v85, v101, v85, s[50:51]
    v_cndmask_b32 v86, v102, v86, s[52:53]
    v_cndmask_b32 v87, v103, v87, s[54:55]
    v_cndmask_b32 v88, v104, v88, s[56:57]
    v_cndmask_b32 v89, v105, v89, s[58:59]
    v_cndmask_b32 v90, v106, v90, s[60:61]
    v_cndmask_b32 v91, v107, v91, s[62:63]
    v_cndmask_b32 v92, v108, v92, s[64:65]
    v_cndmask_b32 v93, v109, v93, s[66:67]
    v_cndmask_b32 v94, v110, v94, s[68:69]
    v_cndmask_b32 v95, v111, v95, s[70:71]
    v_max3_f32 v4, v4, v80, v81
    v_max3_f32 v4, v4, v82, v83
    v_max3_f32 v4, v4, v84, v85
    v_max3_f32 v4, v4, v86, v87
    v_max3_f32 v4, v4, v88, v89
    v_max3_f32 v4, v4, v90, v91
    v_max3_f32 v4, v4, v92, v93
    v_max3_f32 v4, v4, v94, v95
    v_mov_b32 v250, v4
    s_nop 1
    v_permlane32_swap_b32 v250, v4
    v_max_f32 v4, v4, v250
    v_sub_f32_e64 v4, 0, v4
    v_mov_b32 v16, 0xf149f2ca
    v_mov_b32 v17, 0xf149f2ca
    v_mov_b32 v18, 0xf149f2ca
    v_mov_b32 v19, 0xf149f2ca
    v_mov_b32 v20, 0xf149f2ca
    v_mov_b32 v21, 0xf149f2ca
    v_mov_b32 v22, 0xf149f2ca
    v_mov_b32 v23, 0xf149f2ca
    v_mov_b32 v24, 0xf149f2ca
    v_mov_b32 v25, 0xf149f2ca
    v_mov_b32 v26, 0xf149f2ca
    v_mov_b32 v27, 0xf149f2ca
    v_mov_b32 v28, 0xf149f2ca
    v_mov_b32 v29, 0xf149f2ca
    v_mov_b32 v30, 0xf149f2ca
    v_mov_b32 v31, 0xf149f2ca
    s_max_u32 s36, s36, 1
    s_cmp_eq_u32 s36, 1
    s_cbranch_scc1 L_g_220
L_gb_221:
    v_mfma_f32_32x32x16_bf16 v[64:79], v[136:139], v[240:243], v[16:31]
    v_add_f32 v80, v80, v4
    v_add_f32 v81, v81, v4
    v_add_f32 v82, v82, v4
    v_add_f32 v83, v83, v4
    v_add_f32 v84, v84, v4
    v_add_f32 v85, v85, v4
    v_add_f32 v86, v86, v4
    v_add_f32 v87, v87, v4
    v_add_f32 v88, v88, v4
    v_add_f32 v89, v89, v4
    v_add_f32 v90, v90, v4
    v_add_f32 v91, v91, v4
    v_add_f32 v92, v92, v4
    v_add_f32 v93, v93, v4
    v_add_f32 v94, v94, v4
    v_add_f32 v95, v95, v4
    v_exp_f32 v80, v80
    v_exp_f32 v81, v81
    v_exp_f32 v82, v82
    v_exp_f32_e64 v83, v83
    v_cvt_pk_bf16_f32 v200, v80, v81
    v_exp_f32 v84, v84
    v_exp_f32 v85, v85
    v_cvt_pk_bf16_f32 v201, v82, v83
    v_exp_f32 v86, v86
    v_exp_f32 v87, v87
    v_cvt_pk_bf16_f32 v202, v84, v85
    v_exp_f32_e64 v88, v88
    v_mfma_f32_32x32x16_bf16 v[64:79], v[140:143], v[244:247], v[64:79]
    v_exp_f32_e64 v89, v89
    v_cvt_pk_bf16_f32 v203, v86, v87
    v_exp_f32 v90, v90
    v_exp_f32 v91, v91
    v_cvt_pk_bf16_f32 v204, v88, v89
    v_exp_f32 v92, v92
    v_exp_f32 v93, v93
    v_cvt_pk_bf16_f32 v205, v90, v91
    v_exp_f32 v94, v94
    v_exp_f32 v95, v95
    v_cvt_pk_bf16_f32 v206, v92, v93
    v_cvt_pk_bf16_f32 v207, v94, v95
    v_and_b32 v208, v200, v56
    v_xor_b32 v216, v200, v208
    v_and_b32 v209, v201, v57
    v_xor_b32 v217, v201, v209
    v_and_b32 v210, v202, v58
    v_xor_b32 v218, v202, v210
    v_and_b32 v211, v203, v59
    v_xor_b32 v219, v203, v211
    v_and_b32 v212, v204, v60
    v_xor_b32 v220, v204, v212
    v_and_b32 v213, v205, v61
    v_xor_b32 v221, v205, v213
    v_and_b32 v214, v206, v62
    v_xor_b32 v222, v206, v214
    v_and_b32 v215, v207, v63
    v_xor_b32 v223, v207, v215
    s_cmp_eq_u32 s36, 2
    s_cbranch_scc1 L_g_224
L_gb_225:
    v_mfma_f32_32x32x16_bf16 v[32:47], v[144:147], v[240:243], v[16:31]
    v_exp_f32 v64, v64
    v_exp_f32 v65, v65
    v_exp_f32 v66, v66
    v_exp_f32 v67, v67
    v_mfma_f32_32x32x16_bf16 v[32:47], v[148:151], v[244:247], v[32:47]
    v_cvt_pk_bf16_f32 v200, v64, v65
    v_exp_f32 v68, v68
    v_exp_f32 v69, v69
    v_cvt_pk_bf16_f32 v201, v66, v67
    s_waitcnt lgkmcnt(0)
    v_mfma_f32_32x32x16_bf16 v[96:111], v[224:227], v[216:219], 0
    v_exp_f32 v70, v70
    v_exp_f32_e64 v71, v71
    v_cvt_pk_bf16_f32 v202, v68, v69
    v_exp_f32_e64 v72, v72
    v_mfma_f32_32x32x16_bf16 v[96:111], v[228:231], v[220:223], v[96:111]
    ds_read_b128 v[224:227], v3 offset:2048
    ds_read_b128 v[228:231], v3 offset:3072
    v_exp_f32_e64 v73, v73
    v_cvt_pk_bf16_f32 v203, v70, v71
    v_exp_f32 v74, v74
    v_exp_f32 v75, v75
    v_mfma_f32_32x32x16_bf16 v[96:111], v[232:235], v[208:211], v[96:111]
    v_cvt_pk_bf16_f32 v204, v72, v73
    v_exp_f32 v76, v76
    v_exp_f32 v77, v77
    v_cvt_pk_bf16_f32 v205, v74, v75
    v_mfma_f32_32x32x16_bf16 v[96:111], v[236:239], v[212:215], v[96:111]
    ds_read_b128 v[232:235], v3 offset:4096
    ds_read_b128 v[236:239], v3 offset:5120
    v_exp_f32 v78, v78
    v_exp_f32 v79, v79
    v_cvt_pk_bf16_f32 v206, v76, v77
    v_cvt_pk_bf16_f32 v207, v78, v79
    s_cmp_eq_u32 s36, 3
    s_cbranch_scc1 L_g_226
L_gb_227:
    v_mfma_f32_32x32x16_bf16 v[64:79], v[152:155], v[240:243], v[16:31]
    v_exp_f32 v32, v32
    v_exp_f32 v33, v33
    v_exp_f32 v34, v34
    v_exp_f32 v35, v35
    v_cvt_pk_bf16_f32 v208, v32, v33
    v_exp_f32_e64 v36, v36
    v_mfma_f32_32x32x16_bf16 v[64:79], v[156:159], v[244:247], v[64:79]
    v_exp_f32_e64 v37, v37
    v_cvt_pk_bf16_f32 v209, v34, v35
    v_exp_f32 v38, v38
    v_exp_f32 v39, v39
    v_cvt_pk_bf16_f32 v210, v36, v37
    v_exp_f32 v40, v40
    s_waitcnt lgkmcnt(2)
    v_mfma_f32_32x32x16_bf16 v[96:111], v[224:227], v[200:203], v[96:111]
    v_exp_f32_e64 v41, v41
    v_cvt_pk_bf16_f32 v211, v38, v39
    v_exp_f32 v42, v42
    v_exp_f32 v43, v43
    v_cvt_pk_bf16_f32 v212, v40, v41
    v_exp_f32_e64 v44, v44
    v_mfma_f32_32x32x16_bf16 v[96:111], v[228:231], v[204:207], v[96:111]
    ds_read_b128 v[224:227], v3 offset:6144
    ds_read_b128 v[228:231], v3 offset:7168
    v_exp_f32_e64 v45, v45
    v_cvt_pk_bf16_f32 v213, v42, v43
    v_exp_f32 v46, v46
    v_exp_f32 v47, v47
    v_cvt_pk_bf16_f32 v214, v44, v45
    v_cvt_pk_bf16_f32 v215, v46, v47
    s_cmp_eq_u32 s36, 4
    s_cbranch_scc1 L_g_228
L_gb_229:
    v_mfma_f32_32x32x16_bf16 v[32:47], v[160:163], v[240:243], v[16:31]
    v_exp_f32 v64, v64
    v_exp_f32 v65, v65
    v_exp_f32 v66, v66
    v_exp_f32 v67, v67
    v_cvt_pk_bf16_f32 v200, v64, v65
    v_exp_f32_e64 v68, v68
    v_mfma_f32_32x32x16_bf16 v[32:47], v[164:167], v[244:247], v[32:47]
    v_exp_f32_e64 v69, v69
    v_cvt_pk_bf16_f32 v201, v66, v67
    v_exp_f32 v70, v70
    v_exp_f32 v71, v71
    v_cvt_pk_bf16_f32 v202, v68, v69
    v_exp_f32 v72, v72
    s_waitcnt lgkmcnt(2)
    v_mfma_f32_32x32x16_bf16 v[96:111], v[232:235], v[208:211], v[96:111]
    v_exp_f32_e64 v73, v73
    v_cvt_pk_bf16_f32 v203, v70, v71
    v_exp_f32 v74, v74
    v_exp_f32 v75, v75
    v_cvt_pk_bf16_f32 v204, v72, v73
    v_exp_f32_e64 v76, v76
    v_mfma_f32_32x32x16_bf16 v[96:111], v[236:239], v[212:215], v[96:111]
    ds_read_b128 v[232:235], v3 offset:8192
    ds_read_b128 v[236:239], v3 offset:9216
    v_exp_f32_e64 v77, v77
    v_cvt_pk_bf16_f32 v205, v74, v75
    v_exp_f32 v78, v78
    v_exp_f32 v79, v79
    v_cvt_pk_bf16_f32 v206, v76, v77
    v_cvt_pk_bf16_f32 v207, v78, v79
    s_cmp_eq_u32 s36, 5
    s_cbranch_scc1 L_g_230
L_gb_231:
    v_mfma_f32_32x32x16_bf16 v[64:79], v[168:171], v[240:243], v[16:31]
    v_exp_f32 v32, v32
    v_exp_f32 v33, v33
    v_exp_f32 v34, v34
    v_exp_f32 v35, v35
    v_cvt_pk_bf16_f32 v208, v32, v33
    v_exp_f32_e64 v36, v36
    v_mfma_f32_32x32x16_bf16 v[64:79], v[172:175], v[244:247], v[64:79]
    v_exp_f32_e64 v37, v37
    v_cvt_pk_bf16_f32 v209, v34, v35
    v_exp_f32 v38, v38
    v_exp_f32 v39, v39
    v_cvt_pk_bf16_f32 v210, v36, v37
    v_exp_f32 v40, v40
    s_waitcnt lgkmcnt(2)
    v_mfma_f32_32x32x16_bf16 v[96:111], v[224:227], v[200:203], v[96:111]
    v_exp_f32_e64 v41, v41
    v_cvt_pk_bf16_f32 v211, v38, v39
    v_exp_f32 v42, v42
    v_exp_f32 v43, v43
    v_cvt_pk_bf16_f32 v212, v40, v41
    v_exp_f32_e64 v44, v44
    v_mfma_f32_32x32x16_bf16 v[96:111], v[228:231], v[204:207], v[96:111]
    ds_read_b128 v[224:227], v3 offset:10240
    ds_read_b128 v[228:231], v3 offset:11264
    v_exp_f32_e64 v45, v45
    v_cvt_pk_bf16_f32 v213, v42, v43
    v_exp_f32 v46, v46
    v_exp_f32 v47, v47
    v_cvt_pk_bf16_f32 v214, v44, v45
    v_cvt_pk_bf16_f32 v215, v46, v47
    s_cmp_eq_u32 s36, 6
    s_cbranch_scc1 L_g_232
L_gb_233:
    v_mfma_f32_32x32x16_bf16 v[32:47], v[176:179], v[240:243], v[16:31]
    v_exp_f32 v64, v64
    v_exp_f32 v65, v65
    v_exp_f32 v66, v66
    v_exp_f32 v67, v67
    v_cvt_pk_bf16_f32 v200, v64, v65
    v_exp_f32_e64 v68, v68
    v_mfma_f32_32x32x16_bf16 v[32:47], v[180:183], v[244:247], v[32:47]
    v_exp_f32_e64 v69, v69
    v_cvt_pk_bf16_f32 v201, v66, v67
    v_exp_f32 v70, v70
    v_exp_f32 v71, v71
    v_cvt_pk_bf16_f32 v202, v68, v69
    v_exp_f32 v72, v72
    s_waitcnt lgkmcnt(2)
    v_mfma_f32_32x32x16_bf16 v[96:111], v[232:235], v[208:211], v[96:111]
    v_exp_f32_e64 v73, v73
    v_cvt_pk_bf16_f32 v203, v70, v71
    v_exp_f32 v74, v74
    v_exp_f32 v75, v75
    v_cvt_pk_bf16_f32 v204, v72, v73
    v_exp_f32_e64 v76, v76
    v_mfma_f32_32x32x16_bf16 v[96:111], v[236:239], v[212:215], v[96:111]
    ds_read_b128 v[232:235], v3 offset:12288
    ds_read_b128 v[236:239], v3 offset:13312
    v_exp_f32_e64 v77, v77
    v_cvt_pk_bf16_f32 v205, v74, v75
    v_exp_f32 v78, v78
    v_exp_f32 v79, v79
    v_cvt_pk_bf16_f32 v206, v76, v77
    v_cvt_pk_bf16_f32 v207, v78, v79
    s_cmp_eq_u32 s36, 7
    s_cbranch_scc1 L_g_234
L_gb_235:
    v_mfma_f32_32x32x16_bf16 v[64:79], v[184:187], v[240:243], v[16:31]
    v_exp_f32 v32, v32
    v_exp_f32 v33, v33
    v_exp_f32 v34, v34
    v_exp_f32 v35, v35
    v_cvt_pk_bf16_f32 v208, v32, v33
    v_exp_f32_e64 v36, v36
    v_mfma_f32_32x32x16_bf16 v[64:79], v[188:191], v[244:247], v[64:79]
    v_exp_f32_e64 v37, v37
    v_cvt_pk_bf16_f32 v209, v34, v35
    v_exp_f32 v38, v38
    v_exp_f32 v39, v39
    v_cvt_pk_bf16_f32 v210, v36, v37
    v_exp_f32 v40, v40
    s_waitcnt lgkmcnt(2)
    v_mfma_f32_32x32x16_bf16 v[96:111], v[224:227], v[200:203], v[96:111]
    v_exp_f32_e64 v41, v41
    v_cvt_pk_bf16_f32 v211, v38, v39
    v_exp_f32 v42, v42
    v_exp_f32 v43, v43
    v_cvt_pk_bf16_f32 v212, v40, v41
    v_exp_f32_e64 v44, v44
    v_mfma_f32_32x32x16_bf16 v[96:111], v[228:231], v[204:207], v[96:111]
    ds_read_b128 v[224:227], v3 offset:14336
    ds_read_b128 v[228:231], v3 offset:15360
    ds_read_b32 v5, v9 offset:176
    v_exp_f32_e64 v45, v45
    v_cvt_pk_bf16_f32 v213, v42, v43
    v_exp_f32 v46, v46
    v_exp_f32 v47, v47
    v_cvt_pk_bf16_f32 v214, v44, v45
    v_cvt_pk_bf16_f32 v215, v46, v47
    s_waitcnt lgkmcnt(0)
    v_cmp_gt_u32 vcc, 1, v5
    s_cbranch_vccnz L_slow_222
L_back_223:
    ds_read_b32 v5, v8
    ds_read_b32 v6, v10 offset:208
    v_mfma_f32_32x32x16_bf16 v[96:111], v[232:235], v[208:211], v[96:111]
    v_exp_f32 v64, v64
    v_exp_f32 v65, v65
    v_exp_f32 v66, v66
    v_exp_f32_e64 v67, v67
    v_cvt_pk_bf16_f32 v200, v64, v65
    v_exp_f32 v68, v68
    v_exp_f32 v69, v69
    v_cvt_pk_bf16_f32 v201, v66, v67
    v_exp_f32 v70, v70
    v_exp_f32 v71, v71
    v_cvt_pk_bf16_f32 v202, v68, v69
    v_exp_f32_e64 v72, v72
    v_mfma_f32_32x32x16_bf16 v[96:111], v[236:239], v[212:215], v[96:111]
    v_exp_f32_e64 v73, v73
    v_cvt_pk_bf16_f32 v203, v70, v71
    v_exp_f32 v74, v74
    v_exp_f32 v75, v75
    v_cvt_pk_bf16_f32 v204, v72, v73
    v_exp_f32 v76, v76
    v_exp_f32 v77, v77
    v_cvt_pk_bf16_f32 v205, v74, v75
    v_exp_f32 v78, v78
    v_exp_f32 v79, v79
    v_cvt_pk_bf16_f32 v206, v76, v77
    v_cvt_pk_bf16_f32 v207, v78, v79
    v_mfma_f32_32x32x16_bf16 v[96:111], v[224:227], v[200:203], v[96:111]
    s_nop 0
    v_mfma_f32_32x32x16_bf16 v[96:111], v[228:231], v[204:207], v[96:111]
    s_waitcnt lgkmcnt(0)
    s_nop 10
    v_mov_b32 v250, v111
    v_mov_b32_e64 v251, v111
    s_nop 1
    v_permlane32_swap_b32 v250, v251
    s_branch L_ctail2
L_grc_69:
    s_mov_b32 s3, 0
L_gr_67:
    s_load_dwordx8 s[44:51], s[56:57], 0 glc
    s_add_u32 s3, s3, 1
    s_cmp_gt_u32 s3, 60000
    s_cbranch_scc1 L_abort
    s_waitcnt lgkmcnt(0)
    s_xor_b32 s29, s46, s2
    s_xor_b32 s30, s47, s2
    s_or_b32 s29, s29, s30
    s_cbranch_scc1 L_gr_67
    s_branch L_grx_68
L_slow_70:
    s_mov_b32 s3, 0
L_slow_70_s:
    ds_read_b128 v[28:31], v10 offset:112
    s_add_u32 s3, s3, 1
    s_cmp_gt_u32 s3, 60000
    s_cbranch_scc1 L_abort
    s_waitcnt lgkmcnt(0)
    v_min3_u32 v28, v28, v29, v30
    v_min_u32_e64 v28, v28, v31
    v_cmp_gt_u32 vcc, 2, v28
    s_cbranch_vccnz L_slow_70_s
    s_branch L_back_71
L_slow_72:
    s_mov_b32 s3, 0
L_slow_72_s:
    ds_read_b128 v[20:23], v10 offset:160
    s_add_u32 s3, s3, 1
    s_cmp_gt_u32 s3, 60000
    s_cbranch_scc1 L_abort
    s_waitcnt lgkmcnt(0)
    v_min3_u32 v20, v20, v21, v22
    v_min_u32 v20, v20, v23
    v_cmp_gt_u32 vcc, 2, v20
    s_cbranch_vccnz L_slow_72_s
    s_branch L_back_73
L_slow_74:
    s_mov_b32 s3, 0
L_slow_74_s:
    s_sleep 4
    s_add_u32 s31, s58, 0
    buffer_load_dwordx4 v[64:67], v6, s[32:35], s31 offen offset:0 sc1
    buffer_load_dwordx4 v[68:71], v6, s[32:35], s31 offen offset:1024 sc1
    buffer_load_dwordx4 v[72:75], v6, s[32:35], s31 offen offset:2048 sc1
    buffer_load_dwordx4 v[76:79], v6, s[32:35], s31 offen offset:3072 sc1
    s_add_u32 s3, s3, 1
    s_cmp_gt_u32 s3, 60000
    s_cbranch_scc1 L_abort
    s_waitcnt vmcnt(0)
    v_xor_b32 v67, v67, v9
    v_xor_b32 v71, v71, v9
    v_xor_b32 v75, v75, v9
    v_xor_b32_e64 v79, v79, v9
    v_or3_b32 v7, v67, v71, v75
    v_or_b32_e64 v7, v7, v79
    v_cmp_lt_u32 vcc, 0xffff, v7
    s_cbranch_vccnz L_slow_74_s
    s_branch L_back_75
L_grc_78:
    s_mov_b32 s3, 0
L_gr_76:
    s_load_dwordx8 s[44:51], s[56:57], 0 glc
    s_add_u32 s3, s3, 1
    s_cmp_gt_u32 s3, 60000
    s_cbranch_scc1 L_abort
    s_waitcnt lgkmcnt(0)
    s_xor_b32 s29, s48, s2
    s_xor_b32 s30, s49, s2
    s_or_b32 s29, s29, s30
    s_cbranch_scc1 L_gr_76
    s_branch L_grx_77
L_slow_79:
    s_mov_b32 s3, 0
L_slow_79_s:
    s_sleep 4
    s_add_u32 s31, s58, 4096
    buffer_load_dwordx4 v[80:83], v6, s[32:35], s31 offen offset:0 sc1
    buffer_load_dwordx4 v[84:87], v6, s[32:35], s31 offen offset:1024 sc1
    buffer_load_dwordx4 v[88:91], v6, s[32:35], s31 offen offset:2048 sc1
    buffer_load_dwordx4 v[92:95], v6, s[32:35], s31 offen offset:3072 sc1
    s_add_u32 s3, s3, 1
    s_cmp_gt_u32 s3, 60000
    s_cbranch_scc1 L_abort
    s_waitcnt vmcnt(0)
    v_xor_b32 v83, v83, v9
    v_xor_b32 v87, v87, v9
    v_xor_b32 v91, v91, v9
    v_xor_b32 v95, v95, v9
    v_or3_b32 v7, v83, v87, v91
    v_or_b32_e64 v7, v7, v95
    v_cmp_lt_u32 vcc, 0xffff, v7
    s_cbranch_vccnz L_slow_79_s
    s_branch L_back_80
L_grc_83:
    s_mov_b32 s3, 0
L_gr_81:
    s_load_dwordx8 s[44:51], s[56:57], 0 glc
    s_add_u32 s3, s3, 1
    s_cmp_gt_u32 s3, 60000
    s_cbranch_scc1 L_abort
    s_waitcnt lgkmcnt(0)
    s_xor_b32 s29, s50, s2
    s_xor_b32 s30, s51, s2
    s_or_b32 s29, s29, s30
    s_cbranch_scc1 L_gr_81
    s_branch L_grx_82
L_slow_84:
    s_mov_b32 s3, 0
L_slow_84_s:
    s_sleep 4
    s_add_u32 s31, s58, 8192
    buffer_load_dwordx4 v[96:99], v6, s[32:35], s31 offen offset:0 sc1
    buffer_load_dwordx4 v[100:103], v6, s[32:35], s31 offen offset:1024 sc1
    buffer_load_dwordx4 v[104:107], v6, s[32:35], s31 offen offset:2048 sc1
    buffer_load_dwordx4 v[108:111], v6, s[32:35], s31 offen offset:3072 sc1
    s_add_u32 s3, s3, 1
    s_cmp_gt_u32 s3, 60000
    s_cbranch_scc1 L_abort
    s_waitcnt vmcnt(0)
    v_xor_b32 v99, v99, v9
    v_xor_b32 v103, v103, v9
    v_xor_b32 v107, v107, v9
    v_xor_b32 v111, v111, v9
    v_or3_b32 v7, v99, v103, v107
    v_or_b32_e64 v7, v7, v111
    v_cmp_lt_u32 vcc, 0xffff, v7
    s_cbranch_vccnz L_slow_84_s
    s_branch L_back_85
L_slow_86:
    s_mov_b32 s3, 0
L_slow_86_s:
    s_sleep 4
    s_add_u32 s31, s58, 12288
    buffer_load_dwordx4 v[112:115], v6, s[32:35], s31 offen offset:0 sc1
    buffer_load_dwordx4 v[116:119], v6, s[32:35], s31 offen offset:1024 sc1
    buffer_load_dwordx4 v[120:123], v6, s[32:35], s31 offen offset:2048 sc1
    buffer_load_dwordx4 v[124:127], v6, s[32:35], s31 offen offset:3072 sc1
    s_add_u32 s3, s3, 1
    s_cmp_gt_u32 s3, 60000
    s_cbranch_scc1 L_abort
    s_waitcnt vmcnt(0)
    v_xor_b32 v115, v115, v9
    v_xor_b32 v119, v119, v9
    v_xor_b32 v123, v123, v9
    v_xor_b32_e64 v127, v127, v9
    v_or3_b32 v7, v115, v119, v123
    v_or_b32_e64 v7, v7, v127
    v_cmp_lt_u32 vcc, 0xffff, v7
    s_cbranch_vccnz L_slow_86_s
    s_branch L_back_87
L_slow_120:
    s_mov_b32 s3, 0
L_slow_120_s:
    ds_read_b32 v254, v10 offset:292
    s_add_u32 s3, s3, 1
    s_cmp_gt_u32 s3, 60000
    s_cbranch_scc1 L_abort
    s_waitcnt lgkmcnt(0)
    v_cmp_ne_u32 vcc, 2, v254
    s_cbranch_vccnz L_slow_120_s
    s_branch L_back_121
L_slow_122:
    s_mov_b32 s3, 0
L_slow_122_s:
    ds_read_b32 v254, v10 offset:300
    s_add_u32 s3, s3, 1
    s_cmp_gt_u32 s3, 60000
    s_cbranch_scc1 L_abort
    s_waitcnt lgkmcnt(0)
    v_cmp_ne_u32 vcc, 2, v254
    s_cbranch_vccnz L_slow_122_s
    s_branch L_back_123
L_slow_124:
    s_mov_b32 s3, 0
L_slow_124_s:
    ds_read_b32 v254, v10 offset:308
    s_add_u32 s3, s3, 1
    s_cmp_gt_u32 s3, 60000
    s_cbranch_scc1 L_abort
    s_waitcnt lgkmcnt(0)
    v_cmp_ne_u32 vcc, 2, v254
    s_cbranch_vccnz L_slow_124_s
    s_branch L_back_125
L_slow_126:
    s_mov_b32 s3, 0
L_slow_126_s:
    ds_read_b32 v254, v10 offset:312
    s_add_u32 s3, s3, 1
    s_cmp_gt_u32 s3, 60000
    s_cbranch_scc1 L_abort
    s_waitcnt lgkmcnt(0)
    v_cmp_ne_u32 vcc, 2, v254
    s_cbranch_vccnz L_slow_126_s
    s_branch L_back_127
L_slow_128:
    s_mov_b32 s3, 0
L_slow_128_s:
    ds_read_b32 v254, v10 offset:320
    s_add_u32 s3, s3, 1
    s_cmp_gt_u32 s3, 60000
    s_cbranch_scc1 L_abort
    s_waitcnt lgkmcnt(0)
    v_cmp_ne_u32 vcc, 2, v254
    s_cbranch_vccnz L_slow_128_s
    s_branch L_back_129
L_slow_130:
    s_mov_b32 s3, 0
L_slow_130_s:
    ds_read_b32 v254, v10 offset:328
    s_add_u32 s3, s3, 1
    s_cmp_gt_u32 s3, 60000
    s_cbranch_scc1 L_abort
    s_waitcnt lgkmcnt(0)
    v_cmp_ne_u32 vcc, 2, v254
    s_cbranch_vccnz L_slow_130_s
    s_branch L_back_131
L_slow_132:
    s_mov_b32 s3, 0
L_slow_132_s:
    ds_read_b32 v254, v10 offset:336
    s_add_u32 s3, s3, 1
    s_cmp_gt_u32 s3, 60000
    s_cbranch_scc1 L_abort
    s_waitcnt lgkmcnt(0)
    v_cmp_ne_u32 vcc, 2, v254
    s_cbranch_vccnz L_slow_132_s
    s_branch L_back_133
L_slow_162:
    s_mov_b32 s3, 0
L_slow_162_s:
    ds_read_b32 v254, v10 offset:292
    s_add_u32 s3, s3, 1
    s_cmp_gt_u32 s3, 60000
    s_cbranch_scc1 L_abort
    s_waitcnt lgkmcnt(0)
    v_cmp_ne_u32 vcc, 2, v254
    s_cbranch_vccnz L_slow_162_s
    s_branch L_back_163
L_slow_164:
    s_mov_b32 s3, 0
L_slow_164_s:
    ds_read_b32 v254, v10 offset:300
    s_add_u32 s3, s3, 1
    s_cmp_gt_u32 s3, 60000
    s_cbranch_scc1 L_abort
    s_waitcnt lgkmcnt(0)
    v_cmp_ne_u32 vcc, 2, v254
    s_cbranch_vccnz L_slow_164_s
    s_branch L_back_165
L_slow_166:
    s_mov_b32 s3, 0
L_slow_166_s:
    ds_read_b32 v254, v10 offset:308
    s_add_u32 s3, s3, 1
    s_cmp_gt_u32 s3, 60000
    s_cbranch_scc1 L_abort
    s_waitcnt lgkmcnt(0)
    v_cmp_ne_u32 vcc, 2, v254
    s_cbranch_vccnz L_slow_166_s
    s_branch L_back_167
L_slow_168:
    s_mov_b32 s3, 0
L_slow_168_s:
    ds_read_b32 v254, v10 offset:312
    s_add_u32 s3, s3, 1
    s_cmp_gt_u32 s3, 60000
    s_cbranch_scc1 L_abort
    s_waitcnt lgkmcnt(0)
    v_cmp_ne_u32 vcc, 2, v254
    s_cbranch_vccnz L_slow_168_s
    s_branch L_back_169
L_slow_170:
    s_mov_b32 s3, 0
L_slow_170_s:
    ds_read_b32 v254, v10 offset:320
    s_add_u32 s3, s3, 1
    s_cmp_gt_u32 s3, 60000
    s_cbranch_scc1 L_abort
    s_waitcnt lgkmcnt(0)
    v_cmp_ne_u32 vcc, 2, v254
    s_cbranch_vccnz L_slow_170_s
    s_branch L_back_171
L_slow_172:
    s_mov_b32 s3, 0
L_slow_172_s:
    ds_read_b32 v254, v10 offset:328
    s_add_u32 s3, s3, 1
    s_cmp_gt_u32 s3, 60000
    s_cbranch_scc1 L_abort
    s_waitcnt lgkmcnt(0)
    v_cmp_ne_u32 vcc, 2, v254
    s_cbranch_vccnz L_slow_172_s
    s_branch L_back_173
L_slow_174:
    s_mov_b32 s3, 0
L_slow_174_s:
    ds_read_b32 v254, v10 offset:336
    s_add_u32 s3, s3, 1
    s_cmp_gt_u32 s3, 60000
    s_cbranch_scc1 L_abort
    s_waitcnt lgkmcnt(0)
    v_cmp_ne_u32 vcc, 2, v254
    s_cbranch_vccnz L_slow_174_s
    s_branch L_back_175
L_slow_176:
    s_mov_b32 s3, 0
L_slow_176_s:
    ds_read_b32 v252, v10 offset:344
    s_add_u32 s3, s3, 1
    s_cmp_gt_u32 s3, 60000
    s_cbranch_scc1 L_abort
    s_waitcnt lgkmcnt(0)
    v_cmp_ne_u32 vcc, 2, v252
    s_cbranch_vccnz L_slow_176_s
    s_branch L_back_177
L_nf_180:
    s_nop 7
    v_mov_b32 v96, 0xf149f2ca
    v_mov_b32 v97, 0xf149f2ca
    v_mov_b32 v98, 0xf149f2ca
    v_mov_b32 v99, 0xf149f2ca
    v_mov_b32 v100, 0xf149f2ca
    v_mov_b32 v101, 0xf149f2ca
    v_mov_b32 v102, 0xf149f2ca
    v_mov_b32 v103, 0xf149f2ca
    v_mov_b32 v104, 0xf149f2ca
    v_mov_b32 v105, 0xf149f2ca
    v_mov_b32 v106, 0xf149f2ca
    v_mov_b32 v107, 0xf149f2ca
    v_mov_b32 v108, 0xf149f2ca
    v_mov_b32 v109, 0xf149f2ca
    v_mov_b32 v110, 0xf149f2ca
    v_mov_b32 v111, 0xf149f2ca
    s_branch L_nfb_181
L_nc_182:
    v_mov_b32 v16, 0xf149f2ca
    v_mov_b32 v17, 0xf149f2ca
    v_mov_b32 v18, 0xf149f2ca
    v_mov_b32 v19, 0xf149f2ca
    v_mov_b32 v20, 0xf149f2ca
    v_mov_b32 v21, 0xf149f2ca
    v_mov_b32 v22, 0xf149f2ca
    v_mov_b32 v23, 0xf149f2ca
    v_mov_b32 v24, 0xf149f2ca
    v_mov_b32 v25, 0xf149f2ca
    v_mov_b32 v26, 0xf149f2ca
    v_mov_b32 v27, 0xf149f2ca
    v_mov_b32 v28, 0xf149f2ca
    v_mov_b32 v29, 0xf149f2ca
    v_mov_b32 v30, 0xf149f2ca
    v_mov_b32 v31, 0xf149f2ca
    s_branch L_ncb_183
L_slow_184:
    s_mov_b32 s3, 0
L_slow_184_s:
    ds_read_b32 v5, v9 offset:176
    s_add_u32 s3, s3, 1
    s_cmp_gt_u32 s3, 60000
    s_cbranch_scc1 L_abort
    s_waitcnt lgkmcnt(0)
    v_cmp_gt_u32 vcc, 1, v5
    s_cbranch_vccnz L_slow_184_s
    s_branch L_back_185
L_g_186:
    s_nop 7
    v_mov_b32 v16, v4
    v_mov_b32 v17, v4
    v_mov_b32 v18, v4
    v_mov_b32 v19, v4
    v_mov_b32 v20, v4
    v_mov_b32 v21, v4
    v_mov_b32 v22, v4
    v_mov_b32 v23, v4
    v_mov_b32 v24, v4
    v_mov_b32 v25, v4
    v_mov_b32 v26, v4
    v_mov_b32 v27, v4
    v_mov_b32 v28, v4
    v_mov_b32 v29, v4
    v_mov_b32 v30, v4
    v_mov_b32 v31, v4
    s_branch L_gb_187
L_g_188:
    s_nop 7
    v_mov_b32 v16, v4
    v_mov_b32 v17, v4
    v_mov_b32 v18, v4
    v_mov_b32 v19, v4
    v_mov_b32 v20, v4
    v_mov_b32 v21, v4
    v_mov_b32 v22, v4
    v_mov_b32 v23, v4
    v_mov_b32 v24, v4
    v_mov_b32 v25, v4
    v_mov_b32 v26, v4
    v_mov_b32 v27, v4
    v_mov_b32 v28, v4
    v_mov_b32 v29, v4
    v_mov_b32 v30, v4
    v_mov_b32 v31, v4
    s_branch L_gb_189
L_g_190:
    s_nop 7
    v_mov_b32 v16, v4
    v_mov_b32 v17, v4
    v_mov_b32 v18, v4
    v_mov_b32 v19, v4
    v_mov_b32 v20, v4
    v_mov_b32 v21, v4
    v_mov_b32 v22, v4
    v_mov_b32 v23, v4
    v_mov_b32 v24, v4
    v_mov_b32 v25, v4
    v_mov_b32 v26, v4
    v_mov_b32 v27, v4
    v_mov_b32 v28, v4
    v_mov_b32 v29, v4
    v_mov_b32 v30, v4
    v_mov_b32 v31, v4
    s_branch L_gb_191
L_g_192:
    s_nop 7
    v_mov_b32 v16, v4
    v_mov_b32 v17, v4
    v_mov_b32 v18, v4
    v_mov_b32 v19, v4
    v_mov_b32 v20, v4
    v_mov_b32 v21, v4
    v_mov_b32 v22, v4
    v_mov_b32 v23, v4
    v_mov_b32 v24, v4
    v_mov_b32 v25, v4
    v_mov_b32 v26, v4
    v_mov_b32 v27, v4
    v_mov_b32 v28, v4
    v_mov_b32 v29, v4
    v_mov_b32 v30, v4
    v_mov_b32 v31, v4
    s_branch L_gb_193
L_g_194:
    s_nop 7
    v_mov_b32 v16, v4
    v_mov_b32 v17, v4
    v_mov_b32 v18, v4
    v_mov_b32 v19, v4
    v_mov_b32 v20, v4
    v_mov_b32 v21, v4
    v_mov_b32 v22, v4
    v_mov_b32 v23, v4
    v_mov_b32 v24, v4
    v_mov_b32 v25, v4
    v_mov_b32 v26, v4
    v_mov_b32 v27, v4
    v_mov_b32 v28, v4
    v_mov_b32 v29, v4
    v_mov_b32 v30, v4
    v_mov_b32 v31, v4
    s_branch L_gb_195
L_g_196:
    s_nop 7
    v_mov_b32 v16, v4
    v_mov_b32 v17, v4
    v_mov_b32 v18, v4
    v_mov_b32 v19, v4
    v_mov_b32 v20, v4
    v_mov_b32 v21, v4
    v_mov_b32 v22, v4
    v_mov_b32 v23, v4
    v_mov_b32 v24, v4
    v_mov_b32 v25, v4
    v_mov_b32 v26, v4
    v_mov_b32 v27, v4
    v_mov_b32 v28, v4
    v_mov_b32 v29, v4
    v_mov_b32 v30, v4
    v_mov_b32 v31, v4
    s_branch L_gb_197
L_slow_200:
    s_mov_b32 s3, 0
L_slow_200_s:
    ds_read_b32 v252, v10 offset:344
    s_add_u32 s3, s3, 1
    s_cmp_gt_u32 s3, 60000
    s_cbranch_scc1 L_abort
    s_waitcnt lgkmcnt(0)
    v_cmp_ne_u32 vcc, 2, v252
    s_cbranch_vccnz L_slow_200_s
    s_branch L_back_201
L_g_202:
    s_nop 7
    v_mov_b32 v16, 0
    v_mov_b32 v17, 0
    v_mov_b32 v18, 0
    v_mov_b32 v19, 0
    v_mov_b32 v20, 0
    v_mov_b32 v21, 0
    v_mov_b32 v22, 0
    v_mov_b32 v23, 0
    v_mov_b32 v24, 0
    v_mov_b32 v25, 0
    v_mov_b32 v26, 0
    v_mov_b32 v27, 0
    v_mov_b32 v28, 0
    v_mov_b32 v29, 0
    v_mov_b32 v30, 0
    v_mov_b32 v31, 0
    s_branch L_gb_203
L_g_204:
    s_nop 7
    v_mov_b32 v16, 0
    v_mov_b32 v17, 0
    v_mov_b32 v18, 0
    v_mov_b32 v19, 0
    v_mov_b32 v20, 0
    v_mov_b32 v21, 0
    v_mov_b32 v22, 0
    v_mov_b32 v23, 0
    v_mov_b32 v24, 0
    v_mov_b32 v25, 0
    v_mov_b32 v26, 0
    v_mov_b32 v27, 0
    v_mov_b32 v28, 0
    v_mov_b32 v29, 0
    v_mov_b32 v30, 0
    v_mov_b32 v31, 0
    s_branch L_gb_205
L_g_206:
    s_nop 7
    v_mov_b32 v16, 0
    v_mov_b32 v17, 0
    v_mov_b32 v18, 0
    v_mov_b32 v19, 0
    v_mov_b32 v20, 0
    v_mov_b32 v21, 0
    v_mov_b32 v22, 0
    v_mov_b32 v23, 0
    v_mov_b32 v24, 0
    v_mov_b32 v25, 0
    v_mov_b32 v26, 0
    v_mov_b32 v27, 0
    v_mov_b32 v28, 0
    v_mov_b32 v29, 0
    v_mov_b32 v30, 0
    v_mov_b32 v31, 0
    s_branch L_gb_207
L_g_208:
    s_nop 7
    v_mov_b32 v16, 0
    v_mov_b32 v17, 0
    v_mov_b32 v18, 0
    v_mov_b32 v19, 0
    v_mov_b32 v20, 0
    v_mov_b32 v21, 0
    v_mov_b32 v22, 0
    v_mov_b32 v23, 0
    v_mov_b32 v24, 0
    v_mov_b32 v25, 0
    v_mov_b32 v26, 0
    v_mov_b32 v27, 0
    v_mov_b32 v28, 0
    v_mov_b32 v29, 0
    v_mov_b32 v30, 0
    v_mov_b32 v31, 0
    s_branch L_gb_209
L_g_210:
    s_nop 7
    v_mov_b32 v16, 0
    v_mov_b32 v17, 0
    v_mov_b32 v18, 0
    v_mov_b32 v19, 0
    v_mov_b32 v20, 0
    v_mov_b32 v21, 0
    v_mov_b32 v22, 0
    v_mov_b32 v23, 0
    v_mov_b32 v24, 0
    v_mov_b32 v25, 0
    v_mov_b32 v26, 0
    v_mov_b32 v27, 0
    v_mov_b32 v28, 0
    v_mov_b32 v29, 0
    v_mov_b32 v30, 0
    v_mov_b32 v31, 0
    s_branch L_gb_211
L_g_212:
    s_nop 7
    v_mov_b32 v16, 0
    v_mov_b32 v17, 0
    v_mov_b32 v18, 0
    v_mov_b32 v19, 0
    v_mov_b32 v20, 0
    v_mov_b32 v21, 0
    v_mov_b32 v22, 0
    v_mov_b32 v23, 0
    v_mov_b32 v24, 0
    v_mov_b32 v25, 0
    v_mov_b32 v26, 0
    v_mov_b32 v27, 0
    v_mov_b32 v28, 0
    v_mov_b32 v29, 0
    v_mov_b32 v30, 0
    v_mov_b32 v31, 0
    s_branch L_gb_213
L_g_214:
    s_nop 7
    v_mov_b32 v16, 0
    v_mov_b32 v17, 0
    v_mov_b32 v18, 0
    v_mov_b32 v19, 0
    v_mov_b32 v20, 0
    v_mov_b32 v21, 0
    v_mov_b32 v22, 0
    v_mov_b32 v23, 0
    v_mov_b32 v24, 0
    v_mov_b32 v25, 0
    v_mov_b32 v26, 0
    v_mov_b32 v27, 0
    v_mov_b32 v28, 0
    v_mov_b32 v29, 0
    v_mov_b32 v30, 0
    v_mov_b32 v31, 0
    s_branch L_gb_215
L_g_216:
    s_nop 7
    v_mov_b32 v16, 0
    v_mov_b32 v17, 0
    v_mov_b32 v18, 0
    v_mov_b32 v19, 0
    v_mov_b32 v20, 0
    v_mov_b32 v21, 0
    v_mov_b32 v22, 0
    v_mov_b32 v23, 0
    v_mov_b32 v24, 0
    v_mov_b32 v25, 0
    v_mov_b32 v26, 0
    v_mov_b32 v27, 0
    v_mov_b32 v28, 0
    v_mov_b32 v29, 0
    v_mov_b32 v30, 0
    v_mov_b32 v31, 0
    s_branch L_gb_217
L_g_218:
    s_nop 7
    v_mov_b32 v16, 0
    v_mov_b32 v17, 0
    v_mov_b32 v18, 0
    v_mov_b32 v19, 0
    v_mov_b32 v20, 0
    v_mov_b32 v21, 0
    v_mov_b32 v22, 0
    v_mov_b32 v23, 0
    v_mov_b32 v24, 0
    v_mov_b32 v25, 0
    v_mov_b32 v26, 0
    v_mov_b32 v27, 0
    v_mov_b32 v28, 0
    v_mov_b32 v29, 0
    v_mov_b32 v30, 0
    v_mov_b32 v31, 0
    s_branch L_gb_219
L_g_220:
    s_nop 7
    v_mov_b32 v16, v4
    v_mov_b32 v17, v4
    v_mov_b32 v18, v4
    v_mov_b32 v19, v4
    v_mov_b32 v20, v4
    v_mov_b32 v21, v4
    v_mov_b32 v22, v4
    v_mov_b32 v23, v4
    v_mov_b32 v24, v4
    v_mov_b32 v25, v4
    v_mov_b32 v26, v4
    v_mov_b32 v27, v4
    v_mov_b32 v28, v4
    v_mov_b32 v29, v4
    v_mov_b32 v30, v4
    v_mov_b32_e64 v31, v4
    s_branch L_gb_221
L_slow_222:
    s_mov_b32 s3, 0
L_slow_222_s:
    ds_read_b32 v5, v9 offset:176
    s_add_u32 s3, s3, 1
    s_cmp_gt_u32 s3, 60000
    s_cbranch_scc1 L_abort
    s_waitcnt lgkmcnt(0)
    v_cmp_gt_u32 vcc, 1, v5
    s_cbranch_vccnz L_slow_222_s
    s_branch L_back_223
L_g_224:
    s_nop 7
    v_mov_b32 v16, v4
    v_mov_b32 v17, v4
    v_mov_b32 v18, v4
    v_mov_b32 v19, v4
    v_mov_b32 v20, v4
    v_mov_b32 v21, v4
    v_mov_b32 v22, v4
    v_mov_b32 v23, v4
    v_mov_b32 v24, v4
    v_mov_b32 v25, v4
    v_mov_b32 v26, v4
    v_mov_b32 v27, v4
    v_mov_b32 v28, v4
    v_mov_b32 v29, v4
    v_mov_b32 v30, v4
    v_mov_b32 v31, v4
    s_branch L_gb_225
L_g_226:
    s_nop 7
    v_mov_b32 v16, v4
    v_mov_b32 v17, v4
    v_mov_b32 v18, v4
    v_mov_b32 v19, v4
    v_mov_b32 v20, v4
    v_mov_b32 v21, v4
    v_mov_b32 v22, v4
    v_mov_b32 v23, v4
    v_mov_b32 v24, v4
    v_mov_b32 v25, v4
    v_mov_b32 v26, v4
    v_mov_b32 v27, v4
    v_mov_b32 v28, v4
    v_mov_b32 v29, v4
    v_mov_b32 v30, v4
    v_mov_b32 v31, v4
    s_branch L_gb_227
L_g_228:
    s_nop 7
    v_mov_b32 v16, v4
    v_mov_b32 v17, v4
    v_mov_b32 v18, v4
    v_mov_b32 v19, v4
    v_mov_b32 v20, v4
    v_mov_b32 v21, v4
    v_mov_b32 v22, v4
    v_mov_b32 v23, v4
    v_mov_b32 v24, v4
    v_mov_b32 v25, v4
    v_mov_b32 v26, v4
    v_mov_b32 v27, v4
    v_mov_b32 v28, v4
    v_mov_b32 v29, v4
    v_mov_b32 v30, v4
    v_mov_b32 v31, v4
    s_branch L_gb_229
L_g_230:
    s_nop 7
    v_mov_b32 v16, v4
    v_mov_b32 v17, v4
    v_mov_b32 v18, v4
    v_mov_b32 v19, v4
    v_mov_b32 v20, v4
    v_mov_b32 v21, v4
    v_mov_b32 v22, v4
    v_mov_b32 v23, v4
    v_mov_b32 v24, v4
    v_mov_b32 v25, v4
    v_mov_b32 v26, v4
    v_mov_b32 v27, v4
    v_mov_b32 v28, v4
    v_mov_b32 v29, v4
    v_mov_b32 v30, v4
    v_mov_b32 v31, v4
    s_branch L_gb_231
L_g_232:
    s_nop 7
    v_mov_b32 v16, v4
    v_mov_b32 v17, v4
    v_mov_b32 v18, v4
    v_mov_b32 v19, v4
    v_mov_b32 v20, v4
    v_mov_b32 v21, v4
    v_mov_b32 v22, v4
    v_mov_b32 v23, v4
    v_mov_b32 v24, v4
    v_mov_b32 v25, v4
    v_mov_b32 v26, v4
    v_mov_b32 v27, v4
    v_mov_b32 v28, v4
    v_mov_b32 v29, v4
    v_mov_b32 v30, v4
    v_mov_b32 v31, v4
    s_branch L_gb_233
L_g_234:
    s_nop 7
    v_mov_b32 v16, v4
    v_mov_b32 v17, v4
    v_mov_b32 v18, v4
    v_mov_b32 v19, v4
    v_mov_b32 v20, v4
    v_mov_b32 v21, v4
    v_mov_b32 v22, v4
    v_mov_b32 v23, v4
    v_mov_b32 v24, v4
    v_mov_b32 v25, v4
    v_mov_b32 v26, v4
    v_mov_b32 v27, v4
    v_mov_b32 v28, v4
    v_mov_b32 v29, v4
    v_mov_b32 v30, v4
    v_mov_b32 v31, v4
    s_branch L_gb_235
L_abort:
L_exit:
    s_endpgm
L_end:
.section .rodata,"a"
.p2align 6
.amdhsa_kernel gated_mix__sliding_block__linear_attn_block__prompt_kernel
  .amdhsa_next_free_vgpr 256
  .amdhsa_next_free_sgpr 102
  .amdhsa_accum_offset 256
  .amdhsa_group_segment_fixed_size 0
  .amdhsa_kernarg_size 80
  .amdhsa_user_sgpr_count 2
  .amdhsa_user_sgpr_kernarg_segment_ptr 1
  .amdhsa_system_sgpr_workgroup_id_x 1
.end_amdhsa_kernel
```
